```python
import torch

def _softmax(x, axis=-1):
    return torch.softmax(x, dim=axis)
def _gelu(x):
    return torch.nn.functional.gelu(x, approximate="tanh")
def _silu(x):
    return torch.nn.functional.silu(x)
def _sigmoid(x):
    return torch.sigmoid(x)
def _layernorm(x, axis=-1, eps=1e-5):
    m = x.mean(dim=axis, keepdim=True)
    v = x.var(dim=axis, keepdim=True, unbiased=False)
    return (x - m) / torch.sqrt(v + eps)
def _scatter_add(tgt, idx, src, axis=0):
    return tgt.clone().index_add_(axis, idx, src)
def _segment_sum(src, seg, n):
    out = torch.zeros((n,) + src.shape[1:], dtype=src.dtype)
    return out.index_add_(0, seg, src)
def _pad(x, pw):
    flat = tuple(v for pair in reversed(pw) for v in pair)
    return torch.nn.functional.pad(x, flat)

kernel_name = 'concat_heads__sliding_block_cached__mha_block_cached__decode'

def setup_inputs():

    _w = (lambda a: (lambda t: t.to(torch.bfloat16) if t.is_floating_point() else t)(torch.as_tensor(a)))
    def _A_setup():
        B, Sq, D = 1, 1, 1024
        Hq, Hkv, Sk, Dh = 32, 4, 32768, 128
        assert Hq % Hkv == 0, (Hq, Hkv)
        return {
            "x": _w((lambda *s: torch.randn(*s, dtype=torch.bfloat16) * 0.8)(B, Sq, D)),
            "k_cache": _w((lambda *s: torch.randn(*s, dtype=torch.bfloat16) * 1.6)(B, Hkv, Sk, Dh)),
            "v_cache": _w((lambda *s: torch.randn(*s, dtype=torch.bfloat16) * 0.2)(B, Hkv, Sk, Dh)),
            "wq": _w((lambda *s: torch.randn(*s, dtype=torch.bfloat16) * 1.6)(D, Hq * Dh) * (D ** -0.5)),
            "wo": _w((lambda *s: torch.randn(*s, dtype=torch.bfloat16) * 0.2)(Hq * Dh, D) * ((Hq * Dh) ** -0.5)),
        }
    _A_in = _A_setup()

    def _B_setup():
        B, Sq, D = 1, 1, 1024
        H, Sk, Dh = 32, 32768, 128
        return {
            "x": _w((lambda *s: torch.randn(*s, dtype=torch.bfloat16) * 0.8)(B, Sq, D)),
            "k_cache": _w((lambda *s: torch.randn(*s, dtype=torch.bfloat16) * 1.6)(B, H, Sk, Dh)),
            "v_cache": _w((lambda *s: torch.randn(*s, dtype=torch.bfloat16) * 0.2)(B, H, Sk, Dh)),
            "wq": _w((lambda *s: torch.randn(*s, dtype=torch.bfloat16) * 1.6)(D, H * Dh) * (D ** -0.5)),
            "wo": _w((lambda *s: torch.randn(*s, dtype=torch.bfloat16) * 0.2)(H * Dh, D) * ((H * Dh) ** -0.5)),
        }
    _B_in = _B_setup()

    return {
        "A_x": _A_in["x"],
        "A_k_cache": _A_in["k_cache"],
        "A_v_cache": _A_in["v_cache"],
        "A_wq": _A_in["wq"],
        "A_wo": _A_in["wo"],
        "B_x": _B_in["x"],
        "B_k_cache": _B_in["k_cache"],
        "B_v_cache": _B_in["v_cache"],
        "B_wq": _B_in["wq"],
        "B_wo": _B_in["wo"],
    }

def reference(A_x, A_k_cache, A_v_cache, A_wq, A_wo, B_x, B_k_cache, B_v_cache, B_wq, B_wo):
    def _A_ref(x, k_cache, v_cache, wq, wo):
        B, Sq, D = x.shape
        Hq, Dh = 32, 128
        Hkv, Sk = k_cache.shape[1], k_cache.shape[2]
        W = min(4096, max(256, Sk // 4))
        rep = Hq // Hkv
        q = (lambda x, *d: x.permute(*d))((x @ wq).reshape(B, Sq, Hq, Dh), 0, 2, 1, 3)
        k = (lambda x, n, axis: torch.repeat_interleave(x, n, dim=axis))(k_cache[:, :, Sk - W:, :], rep, axis=1)
        v = (lambda x, n, axis: torch.repeat_interleave(x, n, dim=axis))(v_cache[:, :, Sk - W:, :], rep, axis=1)
        scores = torch.einsum("bhqd,bhkd->bhqk", q, k) * (Dh ** -0.5)
        p = _softmax(scores, axis=-1)
        o = torch.einsum("bhqk,bhkd->bhqd", p, v)
        return (lambda x, *d: x.permute(*d))(o, 0, 2, 1, 3).reshape(B, Sq, Hq * Dh) @ wo

    def _B_ref(x, k_cache, v_cache, wq, wo):
        B, Sq, D = x.shape
        H, Dh = 32, 128
        q = (lambda x, *d: x.permute(*d))((x @ wq).reshape(B, Sq, H, Dh), 0, 2, 1, 3)
        scores = torch.einsum("bhqd,bhkd->bhqk", q, k_cache) * (Dh ** -0.5)
        p = _softmax(scores, axis=-1)
        o = torch.einsum("bhqk,bhkd->bhqd", p, v_cache)
        return (lambda x, *d: x.permute(*d))(o, 0, 2, 1, 3).reshape(B, Sq, H * Dh) @ wo

    a = _A_ref(A_x, A_k_cache, A_v_cache, A_wq, A_wo)
    b = _B_ref(B_x, B_k_cache, B_v_cache, B_wq, B_wo)
    return torch.concatenate([a, b], axis=-1)
```

```asm
; @launch grid=(256,1,1) block=(320,1,1) lds=65536
.amdgcn_target "amdgcn-amd-amdhsa--gfx950"
.text
.globl concat_heads__sliding_block_cached__mha_block_cached__decode_kernel
.p2align 8
.type concat_heads__sliding_block_cached__mha_block_cached__decode_kernel,@function
concat_heads__sliding_block_cached__mha_block_cached__decode_kernel:
  s_cmp_ge_u32 s2, 256
  s_cbranch_scc1 L_end
  s_load_dwordx16 s[4:19], s[0:1], 0
  s_load_dwordx8 s[20:27], s[0:1], 64
  s_load_dwordx2 s[28:29], s[0:1], 96
  v_lshrrev_b32 v1, 6, v0
  v_and_b32 v0, 63, v0
  v_readfirstlane_b32 s3, v1
  s_lshr_b32 s84, s2, 3
  s_and_b32 s85, s2, 7
  s_and_b32 s90, s84, 7
  s_cmp_eq_u32 s90, s85
  s_cselect_b32 s95, 1, 0
  v_lshlrev_b32 v1, 4, v0
  s_cmp_eq_u32 s3, 4
  s_cbranch_scc1 L_helper
  s_mov_b32 s92, 0x3e0293ee
  v_lshrrev_b32 v4, 4, v0
  v_and_b32 v5, 15, v0
  s_mov_b32 s35, 0x20000
  s_mov_b32 s39, 0x20000
  s_mov_b32 s43, 0x20000
  s_mov_b32 s47, 0x20000
  s_mov_b32 s51, 0x20000
  s_mov_b32 s55, 0x20000
  s_mov_b32 s59, 0x20000
  s_mov_b32 s63, 0x20000
  s_mov_b32 s71, 0x20000
  s_mov_b32 s75, 0x20000
  s_mov_b32 s34, 0x800000
  s_mov_b32 s38, 0x800000
  s_mov_b32 s42, 0x800000
  s_mov_b32 s46, 0x800000
  s_mov_b32 s50, 0x800000
  s_mov_b32 s54, 0x800000
  s_mov_b32 s58, 0x20000
  s_mov_b32 s62, 0x20000
  s_mov_b32 s70, 2048
  s_mov_b32 s74, 2048
  v_lshlrev_b32 v2, 13, v4
  v_lshl_add_u32 v2, v5, 4, v2
  v_and_b32 v6, 7, v5
  v_lshl_add_u32 v6, v6, 2, v4
  s_lshl_b32 s90, s3, 5
  v_add_u32 v6, s90, v6
  v_lshlrev_b32 v242, 1, v6
  s_lshl_b32 s91, s85, 7
  s_add_u32 s90, s90, s91
  s_lshl_b32 s90, s90, 13
  s_lshl_b32 s91, s84, 8
  s_add_u32 s90, s90, s91
  s_lshl_b32 s91, s85, 8
  s_waitcnt lgkmcnt(0)
  s_mov_b32 s40, s20
  s_mov_b32 s41, s21
  s_mov_b32 s68, s14
  s_mov_b32 s69, s15
  s_mov_b32 s72, s4
  s_mov_b32 s73, s5
  s_mov_b32 s44, s10
  s_mov_b32 s45, s11
  buffer_load_ushort v28, v242, s[68:71], s91 offen nt
  buffer_load_ushort v248, v242, s[72:75], s91 offen nt
  buffer_load_dwordx4 v[160:163], v2, s[40:43], s90 offen offset:0 nt
  s_add_u32 s93, s90, 32768
  buffer_load_dwordx4 v[164:167], v2, s[40:43], s93 offen offset:0 nt
  s_add_u32 s93, s90, 65536
  buffer_load_dwordx4 v[168:171], v2, s[40:43], s93 offen offset:0 nt
  s_add_u32 s93, s90, 98304
  buffer_load_dwordx4 v[172:175], v2, s[40:43], s93 offen offset:0 nt
  s_add_u32 s93, s90, 131072
  buffer_load_dwordx4 v[176:179], v2, s[40:43], s93 offen offset:0 nt
  s_lshl_b32 s30, s84, 23
  s_add_u32 s32, s16, s30
  s_addc_u32 s33, s17, 0
  s_add_u32 s36, s18, s30
  s_addc_u32 s37, s19, 0
  s_lshl_b32 s86, s85, 2
  s_add_u32 s86, s86, s3
  v_add_u32 v31, 4096, v1
  v_bfe_i32 v244, v0, 4, 1
  v_and_b32 v244, 0x8000, v244
  v_bfe_i32 v245, v0, 5, 1
  v_and_b32 v245, 0x10000, v245
  v_xor_b32 v244, v244, v245
  v_lshl_add_u32 v253, v5, 4, v244
  s_lshl_b32 s30, s2, 7
  s_lshl_b32 s31, s3, 5
  s_or_b32 s30, s30, s31
  v_and_b32 v244, 31, v0
  v_or_b32 v244, s30, v244
  v_bfe_i32 v247, v244, 0, 1
  v_and_b32 v243, 0x200, v247
  v_bfe_i32 v247, v244, 1, 1
  v_and_b32 v247, 0x400000, v247
  v_xor_b32 v243, v243, v247
  v_bfe_i32 v247, v244, 2, 1
  v_and_b32 v247, 0x800, v247
  v_xor_b32 v243, v243, v247
  v_bfe_i32 v247, v244, 3, 1
  v_and_b32 v247, 0x100000, v247
  v_xor_b32 v243, v243, v247
  v_bfe_i32 v247, v244, 4, 1
  v_and_b32 v247, 0x1000, v247
  v_xor_b32 v243, v243, v247
  v_bfe_i32 v247, v244, 5, 1
  v_and_b32 v247, 0x2000, v247
  v_xor_b32 v243, v243, v247
  v_bfe_i32 v247, v244, 6, 1
  v_and_b32 v247, 0x180000, v247
  v_xor_b32 v243, v243, v247
  v_bfe_i32 v247, v244, 7, 1
  v_and_b32 v247, 0x200000, v247
  v_xor_b32 v243, v243, v247
  v_bfe_i32 v247, v244, 8, 1
  v_and_b32 v247, 0x4000, v247
  v_xor_b32 v243, v243, v247
  v_bfe_i32 v247, v244, 9, 1
  v_and_b32 v247, 0x20100, v247
  v_xor_b32 v243, v243, v247
  v_bfe_i32 v247, v244, 10, 1
  v_and_b32 v247, 0x400, v247
  v_xor_b32 v243, v243, v247
  v_bfe_i32 v247, v244, 11, 1
  v_and_b32 v247, 0x120800, v247
  v_xor_b32 v243, v243, v247
  v_bfe_i32 v247, v244, 12, 1
  v_and_b32 v247, 0x200, v247
  v_xor_b32 v243, v243, v247
  v_bfe_i32 v247, v244, 13, 1
  v_and_b32 v247, 0x500000, v247
  v_xor_b32 v243, v243, v247
  v_bfe_i32 v247, v244, 14, 1
  v_and_b32 v247, 0x100, v247
  v_xor_b32 v243, v243, v247
  s_and_b32 s31, s84, 7
  s_lshl_b32 s31, s31, 2
  v_add_u32 v244, 0, v0
  v_mul_u32_u24 v246, 2341, v244
  v_lshrrev_b32 v246, 16, v246
  v_mul_u32_u24 v245, 28, v246
  v_sub_u32 v245, v244, v245
  v_add_u32 v246, 31, v246
  v_cmp_le_u32 vcc, s31, v245
  s_nop 1
  v_cndmask_b32 v247, 0, 4, vcc
  v_add_u32 v245, v245, v247
  v_lshl_add_u32 v245, v245, 5, v246
  v_cmp_gt_u32 vcc, 28, v244
  v_subrev_u32 v244, 28, v244
  v_and_b32 v246, 3, v244
  v_add_u32 v246, s31, v246
  v_lshrrev_b32 v247, 2, v244
  v_add_u32 v247, 25, v247
  v_lshl_add_u32 v246, v246, 5, v247
  v_cndmask_b32 v244, v246, v245, vcc
  s_lshl_b32 s31, s84, 10
  v_and_b32 v244, 0x3ff, v244
  v_or_b32 v244, s31, v244
  v_bfe_i32 v247, v244, 0, 1
  v_and_b32 v254, 0x200, v247
  v_bfe_i32 v247, v244, 1, 1
  v_and_b32 v247, 0x400000, v247
  v_xor_b32 v254, v254, v247
  v_bfe_i32 v247, v244, 2, 1
  v_and_b32 v247, 0x800, v247
  v_xor_b32 v254, v254, v247
  v_bfe_i32 v247, v244, 3, 1
  v_and_b32 v247, 0x100000, v247
  v_xor_b32 v254, v254, v247
  v_bfe_i32 v247, v244, 4, 1
  v_and_b32 v247, 0x1000, v247
  v_xor_b32 v254, v254, v247
  v_bfe_i32 v247, v244, 5, 1
  v_and_b32 v247, 0x2000, v247
  v_xor_b32 v254, v254, v247
  v_bfe_i32 v247, v244, 6, 1
  v_and_b32 v247, 0x180000, v247
  v_xor_b32 v254, v254, v247
  v_bfe_i32 v247, v244, 7, 1
  v_and_b32 v247, 0x200000, v247
  v_xor_b32 v254, v254, v247
  v_bfe_i32 v247, v244, 8, 1
  v_and_b32 v247, 0x4000, v247
  v_xor_b32 v254, v254, v247
  v_bfe_i32 v247, v244, 9, 1
  v_and_b32 v247, 0x20100, v247
  v_xor_b32 v254, v254, v247
  v_bfe_i32 v247, v244, 10, 1
  v_and_b32 v247, 0x400, v247
  v_xor_b32 v254, v254, v247
  v_bfe_i32 v247, v244, 11, 1
  v_and_b32 v247, 0x120800, v247
  v_xor_b32 v254, v254, v247
  v_bfe_i32 v247, v244, 12, 1
  v_and_b32 v247, 0x200, v247
  v_xor_b32 v254, v254, v247
  v_bfe_i32 v247, v244, 13, 1
  v_and_b32 v247, 0x500000, v247
  v_xor_b32 v254, v254, v247
  v_bfe_i32 v247, v244, 14, 1
  v_and_b32 v247, 0x100, v247
  v_xor_b32 v254, v254, v247
  s_lshr_b32 s91, s84, 3
  s_lshl_b32 s91, s91, 23
  s_and_b32 s30, s84, 7
  s_lshl_b32 s30, s30, 17
  s_add_u32 s91, s91, s30
  s_add_u32 s91, s91, 7340032
  s_mov_b32 s48, s22
  s_mov_b32 s49, s23
  s_mov_b32 s52, s12
  s_mov_b32 s53, s13
  s_add_u32 s56, s6, s91
  s_addc_u32 s57, s7, 0
  s_add_u32 s60, s8, s91
  s_addc_u32 s61, s9, 0
  s_lshl_b32 s30, s84, 15
  s_add_u32 s30, s30, 3072
  s_and_b32 s31, s84, 7
  s_lshl_b32 s31, s31, 12
  s_add_u32 s30, s30, s31
  s_lshr_b32 s31, s84, 3
  s_lshl_b32 s31, s31, 8
  s_add_u32 s30, s30, s31
  s_add_u32 s82, s28, s30
  s_addc_u32 s83, s29, 0
  v_lshlrev_b32 v3, 11, v4
  v_lshl_add_u32 v3, v5, 4, v3
  v_lshlrev_b32 v240, 5, v5
  v_lshl_add_u32 v240, v4, 3, v240
  s_mul_i32 s91, s3, 544
  v_add_u32 v240, s91, v240
  s_add_u32 s91, s91, 512
  v_mov_b32 v241, s91
  v_lshlrev_b32 v249, 4, v5
  v_mov_b32 v8, 0
  v_mov_b32 v9, 0
  v_mov_b32 v10, 0
  v_mov_b32 v11, 0
  v_mov_b32 v12, 0
  v_mov_b32 v13, 0
  v_mov_b32 v14, 0
  v_mov_b32 v15, 0
  s_waitcnt vmcnt(4)
  s_add_u32 s93, s90, 163840
  buffer_load_dwordx4 v[180:183], v2, s[40:43], s93 offen offset:0 nt
  v_lshlrev_b32 v29, 16, v28
  v_dot2c_f32_bf16_dpp v8, v28, v160 row_newbcast:0 row_mask:0xf bank_mask:0xf
  s_nop 0
  v_dot2c_f32_bf16_dpp v9, v29, v160 row_newbcast:0 row_mask:0xf bank_mask:0xf
  v_dot2c_f32_bf16_dpp v10, v28, v161 row_newbcast:0 row_mask:0xf bank_mask:0xf
  v_dot2c_f32_bf16_dpp v11, v29, v161 row_newbcast:0 row_mask:0xf bank_mask:0xf
  v_dot2c_f32_bf16_dpp v12, v28, v162 row_newbcast:0 row_mask:0xf bank_mask:0xf
  v_dot2c_f32_bf16_dpp v13, v29, v162 row_newbcast:0 row_mask:0xf bank_mask:0xf
  v_dot2c_f32_bf16_dpp v14, v28, v163 row_newbcast:0 row_mask:0xf bank_mask:0xf
  v_dot2c_f32_bf16_dpp v15, v29, v163 row_newbcast:0 row_mask:0xf bank_mask:0xf
  s_waitcnt vmcnt(4)
  s_add_u32 s93, s90, 196608
  buffer_load_dwordx4 v[184:187], v2, s[40:43], s93 offen offset:0 nt
  v_dot2c_f32_bf16_dpp v8, v28, v164 row_newbcast:1 row_mask:0xf bank_mask:0xf
  v_dot2c_f32_bf16_dpp v9, v29, v164 row_newbcast:1 row_mask:0xf bank_mask:0xf
  v_dot2c_f32_bf16_dpp v10, v28, v165 row_newbcast:1 row_mask:0xf bank_mask:0xf
  v_dot2c_f32_bf16_dpp v11, v29, v165 row_newbcast:1 row_mask:0xf bank_mask:0xf
  v_dot2c_f32_bf16_dpp v12, v28, v166 row_newbcast:1 row_mask:0xf bank_mask:0xf
  v_dot2c_f32_bf16_dpp v13, v29, v166 row_newbcast:1 row_mask:0xf bank_mask:0xf
  v_dot2c_f32_bf16_dpp v14, v28, v167 row_newbcast:1 row_mask:0xf bank_mask:0xf
  v_dot2c_f32_bf16_dpp v15, v29, v167 row_newbcast:1 row_mask:0xf bank_mask:0xf
  s_waitcnt vmcnt(4)
  s_add_u32 s93, s90, 229376
  buffer_load_dwordx4 v[188:191], v2, s[40:43], s93 offen offset:0 nt
  v_dot2c_f32_bf16_dpp v8, v28, v168 row_newbcast:2 row_mask:0xf bank_mask:0xf
  v_dot2c_f32_bf16_dpp v9, v29, v168 row_newbcast:2 row_mask:0xf bank_mask:0xf
  v_dot2c_f32_bf16_dpp v10, v28, v169 row_newbcast:2 row_mask:0xf bank_mask:0xf
  v_dot2c_f32_bf16_dpp v11, v29, v169 row_newbcast:2 row_mask:0xf bank_mask:0xf
  v_dot2c_f32_bf16_dpp v12, v28, v170 row_newbcast:2 row_mask:0xf bank_mask:0xf
  v_dot2c_f32_bf16_dpp v13, v29, v170 row_newbcast:2 row_mask:0xf bank_mask:0xf
  v_dot2c_f32_bf16_dpp v14, v28, v171 row_newbcast:2 row_mask:0xf bank_mask:0xf
  v_dot2c_f32_bf16_dpp v15, v29, v171 row_newbcast:2 row_mask:0xf bank_mask:0xf
  s_waitcnt vmcnt(4)
  buffer_load_dwordx4 v[192:195], v2, s[44:47], s90 offen offset:0 nt
  v_dot2c_f32_bf16_dpp v8, v28, v172 row_newbcast:3 row_mask:0xf bank_mask:0xf
  v_dot2c_f32_bf16_dpp v9, v29, v172 row_newbcast:3 row_mask:0xf bank_mask:0xf
  v_dot2c_f32_bf16_dpp v10, v28, v173 row_newbcast:3 row_mask:0xf bank_mask:0xf
  v_dot2c_f32_bf16_dpp v11, v29, v173 row_newbcast:3 row_mask:0xf bank_mask:0xf
  v_dot2c_f32_bf16_dpp v12, v28, v174 row_newbcast:3 row_mask:0xf bank_mask:0xf
  v_dot2c_f32_bf16_dpp v13, v29, v174 row_newbcast:3 row_mask:0xf bank_mask:0xf
  v_dot2c_f32_bf16_dpp v14, v28, v175 row_newbcast:3 row_mask:0xf bank_mask:0xf
  v_dot2c_f32_bf16_dpp v15, v29, v175 row_newbcast:3 row_mask:0xf bank_mask:0xf
  s_waitcnt vmcnt(4)
  s_add_u32 s93, s90, 32768
  buffer_load_dwordx4 v[196:199], v2, s[44:47], s93 offen offset:0 nt
  v_dot2c_f32_bf16_dpp v8, v28, v176 row_newbcast:4 row_mask:0xf bank_mask:0xf
  v_dot2c_f32_bf16_dpp v9, v29, v176 row_newbcast:4 row_mask:0xf bank_mask:0xf
  v_dot2c_f32_bf16_dpp v10, v28, v177 row_newbcast:4 row_mask:0xf bank_mask:0xf
  v_dot2c_f32_bf16_dpp v11, v29, v177 row_newbcast:4 row_mask:0xf bank_mask:0xf
  v_dot2c_f32_bf16_dpp v12, v28, v178 row_newbcast:4 row_mask:0xf bank_mask:0xf
  v_dot2c_f32_bf16_dpp v13, v29, v178 row_newbcast:4 row_mask:0xf bank_mask:0xf
  v_dot2c_f32_bf16_dpp v14, v28, v179 row_newbcast:4 row_mask:0xf bank_mask:0xf
  v_dot2c_f32_bf16_dpp v15, v29, v179 row_newbcast:4 row_mask:0xf bank_mask:0xf
  s_waitcnt vmcnt(4)
  s_add_u32 s93, s90, 65536
  buffer_load_dwordx4 v[200:203], v2, s[44:47], s93 offen offset:0 nt
  v_dot2c_f32_bf16_dpp v8, v28, v180 row_newbcast:5 row_mask:0xf bank_mask:0xf
  v_dot2c_f32_bf16_dpp v9, v29, v180 row_newbcast:5 row_mask:0xf bank_mask:0xf
  v_dot2c_f32_bf16_dpp v10, v28, v181 row_newbcast:5 row_mask:0xf bank_mask:0xf
  v_dot2c_f32_bf16_dpp v11, v29, v181 row_newbcast:5 row_mask:0xf bank_mask:0xf
  v_dot2c_f32_bf16_dpp v12, v28, v182 row_newbcast:5 row_mask:0xf bank_mask:0xf
  v_dot2c_f32_bf16_dpp v13, v29, v182 row_newbcast:5 row_mask:0xf bank_mask:0xf
  v_dot2c_f32_bf16_dpp v14, v28, v183 row_newbcast:5 row_mask:0xf bank_mask:0xf
  v_dot2c_f32_bf16_dpp v15, v29, v183 row_newbcast:5 row_mask:0xf bank_mask:0xf
  s_waitcnt vmcnt(4)
  s_add_u32 s93, s90, 98304
  buffer_load_dwordx4 v[204:207], v2, s[44:47], s93 offen offset:0 nt
  v_dot2c_f32_bf16_dpp v8, v28, v184 row_newbcast:6 row_mask:0xf bank_mask:0xf
  v_dot2c_f32_bf16_dpp v9, v29, v184 row_newbcast:6 row_mask:0xf bank_mask:0xf
  v_dot2c_f32_bf16_dpp v10, v28, v185 row_newbcast:6 row_mask:0xf bank_mask:0xf
  v_dot2c_f32_bf16_dpp v11, v29, v185 row_newbcast:6 row_mask:0xf bank_mask:0xf
  v_dot2c_f32_bf16_dpp v12, v28, v186 row_newbcast:6 row_mask:0xf bank_mask:0xf
  v_dot2c_f32_bf16_dpp v13, v29, v186 row_newbcast:6 row_mask:0xf bank_mask:0xf
  v_dot2c_f32_bf16_dpp v14, v28, v187 row_newbcast:6 row_mask:0xf bank_mask:0xf
  v_dot2c_f32_bf16_dpp v15, v29, v187 row_newbcast:6 row_mask:0xf bank_mask:0xf
  s_waitcnt vmcnt(4)
  s_add_u32 s93, s90, 131072
  buffer_load_dwordx4 v[208:211], v2, s[44:47], s93 offen offset:0 nt
  v_dot2c_f32_bf16_dpp v8, v28, v188 row_newbcast:7 row_mask:0xf bank_mask:0xf
  v_dot2c_f32_bf16_dpp v9, v29, v188 row_newbcast:7 row_mask:0xf bank_mask:0xf
  v_dot2c_f32_bf16_dpp v10, v28, v189 row_newbcast:7 row_mask:0xf bank_mask:0xf
  v_dot2c_f32_bf16_dpp v11, v29, v189 row_newbcast:7 row_mask:0xf bank_mask:0xf
  v_dot2c_f32_bf16_dpp v12, v28, v190 row_newbcast:7 row_mask:0xf bank_mask:0xf
  v_dot2c_f32_bf16_dpp v13, v29, v190 row_newbcast:7 row_mask:0xf bank_mask:0xf
  v_dot2c_f32_bf16_dpp v14, v28, v191 row_newbcast:7 row_mask:0xf bank_mask:0xf
  v_dot2c_f32_bf16_dpp v15, v29, v191 row_newbcast:7 row_mask:0xf bank_mask:0xf
  v_permlane32_swap_b32 v8, v12
  s_nop 0
  v_permlane32_swap_b32 v10, v14
  v_permlane32_swap_b32 v9, v13
  v_permlane32_swap_b32 v11, v15
  v_add_f32 v8, v8, v12
  v_add_f32 v10, v10, v14
  v_add_f32 v9, v9, v13
  v_add_f32 v11, v11, v15
  v_permlane16_swap_b32 v8, v10
  s_nop 0
  v_permlane16_swap_b32 v9, v11
  v_add_f32 v8, v8, v10
  v_add_f32 v9, v9, v11
  ds_write_b64 v240, v[8:9] offset:0
  s_waitcnt lgkmcnt(0)
  s_barrier
  v_mov_b32 v8, 0
  v_mov_b32 v9, 0
  v_mov_b32 v10, 0
  v_mov_b32 v11, 0
  v_mov_b32 v12, 0
  v_mov_b32 v13, 0
  v_mov_b32 v14, 0
  v_mov_b32 v15, 0
  v_mov_b32 v28, v248
  v_lshlrev_b32 v29, 16, v248
  s_waitcnt vmcnt(4)
  s_add_u32 s93, s90, 163840
  buffer_load_dwordx4 v[212:215], v2, s[44:47], s93 offen offset:0 nt
  v_dot2c_f32_bf16_dpp v8, v28, v192 row_newbcast:0 row_mask:0xf bank_mask:0xf
  v_dot2c_f32_bf16_dpp v9, v29, v192 row_newbcast:0 row_mask:0xf bank_mask:0xf
  v_dot2c_f32_bf16_dpp v10, v28, v193 row_newbcast:0 row_mask:0xf bank_mask:0xf
  v_dot2c_f32_bf16_dpp v11, v29, v193 row_newbcast:0 row_mask:0xf bank_mask:0xf
  v_dot2c_f32_bf16_dpp v12, v28, v194 row_newbcast:0 row_mask:0xf bank_mask:0xf
  v_dot2c_f32_bf16_dpp v13, v29, v194 row_newbcast:0 row_mask:0xf bank_mask:0xf
  v_dot2c_f32_bf16_dpp v14, v28, v195 row_newbcast:0 row_mask:0xf bank_mask:0xf
  v_dot2c_f32_bf16_dpp v15, v29, v195 row_newbcast:0 row_mask:0xf bank_mask:0xf
  s_waitcnt vmcnt(4)
  s_add_u32 s93, s90, 196608
  buffer_load_dwordx4 v[216:219], v2, s[44:47], s93 offen offset:0 nt
  v_dot2c_f32_bf16_dpp v8, v28, v196 row_newbcast:1 row_mask:0xf bank_mask:0xf
  v_dot2c_f32_bf16_dpp v9, v29, v196 row_newbcast:1 row_mask:0xf bank_mask:0xf
  v_dot2c_f32_bf16_dpp v10, v28, v197 row_newbcast:1 row_mask:0xf bank_mask:0xf
  v_dot2c_f32_bf16_dpp v11, v29, v197 row_newbcast:1 row_mask:0xf bank_mask:0xf
  v_dot2c_f32_bf16_dpp v12, v28, v198 row_newbcast:1 row_mask:0xf bank_mask:0xf
  v_dot2c_f32_bf16_dpp v13, v29, v198 row_newbcast:1 row_mask:0xf bank_mask:0xf
  v_dot2c_f32_bf16_dpp v14, v28, v199 row_newbcast:1 row_mask:0xf bank_mask:0xf
  v_dot2c_f32_bf16_dpp v15, v29, v199 row_newbcast:1 row_mask:0xf bank_mask:0xf
  s_waitcnt vmcnt(4)
  s_add_u32 s93, s90, 229376
  buffer_load_dwordx4 v[220:223], v2, s[44:47], s93 offen offset:0 nt
  v_dot2c_f32_bf16_dpp v8, v28, v200 row_newbcast:2 row_mask:0xf bank_mask:0xf
  v_dot2c_f32_bf16_dpp v9, v29, v200 row_newbcast:2 row_mask:0xf bank_mask:0xf
  v_dot2c_f32_bf16_dpp v10, v28, v201 row_newbcast:2 row_mask:0xf bank_mask:0xf
  v_dot2c_f32_bf16_dpp v11, v29, v201 row_newbcast:2 row_mask:0xf bank_mask:0xf
  v_dot2c_f32_bf16_dpp v12, v28, v202 row_newbcast:2 row_mask:0xf bank_mask:0xf
  v_dot2c_f32_bf16_dpp v13, v29, v202 row_newbcast:2 row_mask:0xf bank_mask:0xf
  v_dot2c_f32_bf16_dpp v14, v28, v203 row_newbcast:2 row_mask:0xf bank_mask:0xf
  v_dot2c_f32_bf16_dpp v15, v29, v203 row_newbcast:2 row_mask:0xf bank_mask:0xf
  s_waitcnt vmcnt(4)
  v_readlane_b32 s87, v243, 0
  s_nop 4
  buffer_load_dwordx4 v[32:35], v253, s[32:35], s87 offen offset:0 nt
  v_dot2c_f32_bf16_dpp v8, v28, v204 row_newbcast:3 row_mask:0xf bank_mask:0xf
  v_dot2c_f32_bf16_dpp v9, v29, v204 row_newbcast:3 row_mask:0xf bank_mask:0xf
  v_dot2c_f32_bf16_dpp v10, v28, v205 row_newbcast:3 row_mask:0xf bank_mask:0xf
  v_dot2c_f32_bf16_dpp v11, v29, v205 row_newbcast:3 row_mask:0xf bank_mask:0xf
  v_dot2c_f32_bf16_dpp v12, v28, v206 row_newbcast:3 row_mask:0xf bank_mask:0xf
  v_dot2c_f32_bf16_dpp v13, v29, v206 row_newbcast:3 row_mask:0xf bank_mask:0xf
  v_dot2c_f32_bf16_dpp v14, v28, v207 row_newbcast:3 row_mask:0xf bank_mask:0xf
  v_dot2c_f32_bf16_dpp v15, v29, v207 row_newbcast:3 row_mask:0xf bank_mask:0xf
  s_waitcnt vmcnt(4)
  s_xor_b32 s93, s87, 0x300
  buffer_load_dwordx4 v[36:39], v253, s[32:35], s93 offen offset:0 nt
  v_dot2c_f32_bf16_dpp v8, v28, v208 row_newbcast:4 row_mask:0xf bank_mask:0xf
  v_dot2c_f32_bf16_dpp v9, v29, v208 row_newbcast:4 row_mask:0xf bank_mask:0xf
  v_dot2c_f32_bf16_dpp v10, v28, v209 row_newbcast:4 row_mask:0xf bank_mask:0xf
  v_dot2c_f32_bf16_dpp v11, v29, v209 row_newbcast:4 row_mask:0xf bank_mask:0xf
  v_dot2c_f32_bf16_dpp v12, v28, v210 row_newbcast:4 row_mask:0xf bank_mask:0xf
  v_dot2c_f32_bf16_dpp v13, v29, v210 row_newbcast:4 row_mask:0xf bank_mask:0xf
  v_dot2c_f32_bf16_dpp v14, v28, v211 row_newbcast:4 row_mask:0xf bank_mask:0xf
  v_dot2c_f32_bf16_dpp v15, v29, v211 row_newbcast:4 row_mask:0xf bank_mask:0xf
  s_waitcnt vmcnt(4)
  s_xor_b32 s93, s87, 0x40000
  buffer_load_dwordx4 v[40:43], v253, s[32:35], s93 offen offset:0 nt
  v_dot2c_f32_bf16_dpp v8, v28, v212 row_newbcast:5 row_mask:0xf bank_mask:0xf
  v_dot2c_f32_bf16_dpp v9, v29, v212 row_newbcast:5 row_mask:0xf bank_mask:0xf
  v_dot2c_f32_bf16_dpp v10, v28, v213 row_newbcast:5 row_mask:0xf bank_mask:0xf
  v_dot2c_f32_bf16_dpp v11, v29, v213 row_newbcast:5 row_mask:0xf bank_mask:0xf
  v_dot2c_f32_bf16_dpp v12, v28, v214 row_newbcast:5 row_mask:0xf bank_mask:0xf
  v_dot2c_f32_bf16_dpp v13, v29, v214 row_newbcast:5 row_mask:0xf bank_mask:0xf
  v_dot2c_f32_bf16_dpp v14, v28, v215 row_newbcast:5 row_mask:0xf bank_mask:0xf
  v_dot2c_f32_bf16_dpp v15, v29, v215 row_newbcast:5 row_mask:0xf bank_mask:0xf
  s_waitcnt vmcnt(4)
  s_xor_b32 s93, s87, 0x40300
  buffer_load_dwordx4 v[44:47], v253, s[32:35], s93 offen offset:0 nt
  v_dot2c_f32_bf16_dpp v8, v28, v216 row_newbcast:6 row_mask:0xf bank_mask:0xf
  v_dot2c_f32_bf16_dpp v9, v29, v216 row_newbcast:6 row_mask:0xf bank_mask:0xf
  v_dot2c_f32_bf16_dpp v10, v28, v217 row_newbcast:6 row_mask:0xf bank_mask:0xf
  v_dot2c_f32_bf16_dpp v11, v29, v217 row_newbcast:6 row_mask:0xf bank_mask:0xf
  v_dot2c_f32_bf16_dpp v12, v28, v218 row_newbcast:6 row_mask:0xf bank_mask:0xf
  v_dot2c_f32_bf16_dpp v13, v29, v218 row_newbcast:6 row_mask:0xf bank_mask:0xf
  v_dot2c_f32_bf16_dpp v14, v28, v219 row_newbcast:6 row_mask:0xf bank_mask:0xf
  v_dot2c_f32_bf16_dpp v15, v29, v219 row_newbcast:6 row_mask:0xf bank_mask:0xf
  s_waitcnt vmcnt(4)
  s_xor_b32 s93, s87, 0x200400
  buffer_load_dwordx4 v[48:51], v253, s[32:35], s93 offen offset:0 nt
  v_dot2c_f32_bf16_dpp v8, v28, v220 row_newbcast:7 row_mask:0xf bank_mask:0xf
  v_dot2c_f32_bf16_dpp v9, v29, v220 row_newbcast:7 row_mask:0xf bank_mask:0xf
  v_dot2c_f32_bf16_dpp v10, v28, v221 row_newbcast:7 row_mask:0xf bank_mask:0xf
  v_dot2c_f32_bf16_dpp v11, v29, v221 row_newbcast:7 row_mask:0xf bank_mask:0xf
  v_dot2c_f32_bf16_dpp v12, v28, v222 row_newbcast:7 row_mask:0xf bank_mask:0xf
  v_dot2c_f32_bf16_dpp v13, v29, v222 row_newbcast:7 row_mask:0xf bank_mask:0xf
  v_dot2c_f32_bf16_dpp v14, v28, v223 row_newbcast:7 row_mask:0xf bank_mask:0xf
  v_dot2c_f32_bf16_dpp v15, v29, v223 row_newbcast:7 row_mask:0xf bank_mask:0xf
  v_permlane32_swap_b32 v8, v12
  s_nop 0
  v_permlane32_swap_b32 v10, v14
  v_permlane32_swap_b32 v9, v13
  v_permlane32_swap_b32 v11, v15
  v_add_f32 v8, v8, v12
  v_add_f32 v10, v10, v14
  v_add_f32 v9, v9, v13
  v_add_f32 v11, v11, v15
  v_permlane16_swap_b32 v8, v10
  s_nop 0
  v_permlane16_swap_b32 v9, v11
  v_add_f32 v8, v8, v10
  v_add_f32 v9, v9, v11
  ds_write_b64 v240, v[8:9] offset:2176
  s_waitcnt vmcnt(4)
  s_xor_b32 s93, s87, 0x200700
  buffer_load_dwordx4 v[52:55], v253, s[32:35], s93 offen offset:0 nt
  s_lshl_b32 s90, s84, 7
  s_lshl_b32 s91, s3, 5
  s_add_u32 s90, s90, s91
  s_lshl_b32 s90, s90, 11
  s_lshl_b32 s91, s85, 8
  s_add_u32 s90, s90, s91
  v_mov_b32 v8, 0
  v_mov_b32 v9, 0
  v_mov_b32 v10, 0
  v_mov_b32 v11, 0
  v_mov_b32 v12, 0
  v_mov_b32 v13, 0
  v_mov_b32 v14, 0
  v_mov_b32 v15, 0
  v_mov_b32 v250, 0xff7fffff
  v_mov_b32 v16, 0xff7fffff
  v_mov_b32 v17, 0
  s_lshl_b32 s91, s3, 13
  s_add_u32 s91, s91, 32768
  v_lshrrev_b32 v251, 2, v0
  v_lshl_add_u32 v251, v251, 3, s91
  s_mov_b32 s100, 4
  s_cmp_eq_u32 s95, 1
  s_cselect_b32 s89, 25, 31
  s_waitcnt vmcnt(4)
  s_xor_b32 s93, s87, 0x240400
  buffer_load_dwordx4 v[56:59], v253, s[32:35], s93 offen offset:0 nt
  s_waitcnt vmcnt(4)
  s_xor_b32 s93, s87, 0x240700
  buffer_load_dwordx4 v[60:63], v253, s[32:35], s93 offen offset:0 nt
  s_waitcnt vmcnt(4)
  v_readlane_b32 s87, v243, 1
  s_nop 4
  buffer_load_dwordx4 v[64:67], v253, s[32:35], s87 offen offset:0 nt
  s_waitcnt vmcnt(4)
  s_xor_b32 s93, s87, 0x300
  buffer_load_dwordx4 v[68:71], v253, s[32:35], s93 offen offset:0 nt
  s_waitcnt vmcnt(4)
  s_xor_b32 s93, s87, 0x40000
  buffer_load_dwordx4 v[72:75], v253, s[32:35], s93 offen offset:0 nt
  s_waitcnt vmcnt(4)
  s_xor_b32 s93, s87, 0x40300
  buffer_load_dwordx4 v[76:79], v253, s[32:35], s93 offen offset:0 nt
  s_waitcnt vmcnt(4)
  s_xor_b32 s93, s87, 0x200400
  buffer_load_dwordx4 v[80:83], v253, s[32:35], s93 offen offset:0 nt
  s_waitcnt vmcnt(4)
  s_xor_b32 s93, s87, 0x200700
  buffer_load_dwordx4 v[84:87], v253, s[32:35], s93 offen offset:0 nt
  s_waitcnt vmcnt(4)
  s_xor_b32 s93, s87, 0x240400
  buffer_load_dwordx4 v[88:91], v253, s[32:35], s93 offen offset:0 nt
  s_waitcnt vmcnt(4)
  s_xor_b32 s93, s87, 0x240700
  buffer_load_dwordx4 v[92:95], v253, s[32:35], s93 offen offset:0 nt
  s_waitcnt vmcnt(4)
  v_readlane_b32 s87, v243, 2
  s_nop 4
  buffer_load_dwordx4 v[96:99], v253, s[32:35], s87 offen offset:0 nt
  s_waitcnt lgkmcnt(0)
  s_barrier
  ds_read_b128 v[4:7], v249 offset:28288
  s_waitcnt vmcnt(4)
  s_xor_b32 s93, s87, 0x300
  buffer_load_dwordx4 v[100:103], v253, s[32:35], s93 offen offset:0 nt
  s_waitcnt lgkmcnt(0)
  v_dot2_f32_bf16 v18, v32, v4, 0
  v_dot2_f32_bf16 v18, v33, v5, v18
  v_dot2_f32_bf16 v18, v34, v6, v18
  v_dot2_f32_bf16 v18, v35, v7, v18
  v_dot2_f32_bf16 v19, v36, v4, 0
  v_dot2_f32_bf16 v19, v37, v5, v19
  v_dot2_f32_bf16 v19, v38, v6, v19
  v_dot2_f32_bf16 v19, v39, v7, v19
  v_dot2_f32_bf16 v20, v40, v4, 0
  v_dot2_f32_bf16 v20, v41, v5, v20
  v_dot2_f32_bf16 v20, v42, v6, v20
  v_dot2_f32_bf16 v20, v43, v7, v20
  s_waitcnt vmcnt(4)
  s_xor_b32 s93, s87, 0x40000
  buffer_load_dwordx4 v[104:107], v253, s[32:35], s93 offen offset:0 nt
  v_dot2_f32_bf16 v21, v44, v4, 0
  v_dot2_f32_bf16 v21, v45, v5, v21
  v_dot2_f32_bf16 v21, v46, v6, v21
  v_dot2_f32_bf16 v21, v47, v7, v21
  v_add_f32_dpp v22, v18, v18 row_ror:8 row_mask:0xf bank_mask:0x3
  v_add_f32_dpp v23, v20, v20 row_ror:8 row_mask:0xf bank_mask:0x3
  s_nop 0
  v_add_f32_dpp v22, v19, v19 row_ror:8 row_mask:0xf bank_mask:0xc
  v_add_f32_dpp v23, v21, v21 row_ror:8 row_mask:0xf bank_mask:0xc
  s_nop 0
  v_add_f32_dpp v24, v22, v22 row_half_mirror row_mask:0xf bank_mask:0x5
  s_nop 1
  v_add_f32_dpp v24, v23, v23 row_half_mirror row_mask:0xf bank_mask:0xa
  s_nop 1
  v_add_f32_dpp v24, v24, v24 quad_perm:[1,0,3,2] row_mask:0xf bank_mask:0xf
  s_nop 1
  v_add_f32_dpp v24, v24, v24 quad_perm:[2,3,0,1] row_mask:0xf bank_mask:0xf
  v_max_f32 v250, v250, v24
  ds_write_b32 v251, v24 offset:0
  v_dot2_f32_bf16 v18, v48, v4, 0
  v_dot2_f32_bf16 v18, v49, v5, v18
  v_dot2_f32_bf16 v18, v50, v6, v18
  v_dot2_f32_bf16 v18, v51, v7, v18
  v_dot2_f32_bf16 v19, v52, v4, 0
  v_dot2_f32_bf16 v19, v53, v5, v19
  v_dot2_f32_bf16 v19, v54, v6, v19
  v_dot2_f32_bf16 v19, v55, v7, v19
  s_waitcnt vmcnt(4)
  s_xor_b32 s93, s87, 0x40300
  buffer_load_dwordx4 v[108:111], v253, s[32:35], s93 offen offset:0 nt
  v_dot2_f32_bf16 v20, v56, v4, 0
  v_dot2_f32_bf16 v20, v57, v5, v20
  v_dot2_f32_bf16 v20, v58, v6, v20
  v_dot2_f32_bf16 v20, v59, v7, v20
  v_dot2_f32_bf16 v21, v60, v4, 0
  v_dot2_f32_bf16 v21, v61, v5, v21
  v_dot2_f32_bf16 v21, v62, v6, v21
  v_dot2_f32_bf16 v21, v63, v7, v21
  v_add_f32_dpp v22, v18, v18 row_ror:8 row_mask:0xf bank_mask:0x3
  v_add_f32_dpp v23, v20, v20 row_ror:8 row_mask:0xf bank_mask:0x3
  s_nop 0
  v_add_f32_dpp v22, v19, v19 row_ror:8 row_mask:0xf bank_mask:0xc
  v_add_f32_dpp v23, v21, v21 row_ror:8 row_mask:0xf bank_mask:0xc
  s_nop 0
  v_add_f32_dpp v24, v22, v22 row_half_mirror row_mask:0xf bank_mask:0x5
  s_nop 1
  v_add_f32_dpp v24, v23, v23 row_half_mirror row_mask:0xf bank_mask:0xa
  s_nop 1
  v_add_f32_dpp v24, v24, v24 quad_perm:[1,0,3,2] row_mask:0xf bank_mask:0xf
  s_nop 1
  v_add_f32_dpp v24, v24, v24 quad_perm:[2,3,0,1] row_mask:0xf bank_mask:0xf
  v_max_f32 v250, v250, v24
  ds_write_b32 v251, v24 offset:4
  v_add_u32 v251, 128, v251
  v_dot2_f32_bf16 v18, v64, v4, 0
  v_dot2_f32_bf16 v18, v65, v5, v18
  v_dot2_f32_bf16 v18, v66, v6, v18
  v_dot2_f32_bf16 v18, v67, v7, v18
  s_waitcnt vmcnt(4)
  s_xor_b32 s93, s87, 0x200400
  buffer_load_dwordx4 v[112:115], v253, s[32:35], s93 offen offset:0 nt
  v_dot2_f32_bf16 v19, v68, v4, 0
  v_dot2_f32_bf16 v19, v69, v5, v19
  v_dot2_f32_bf16 v19, v70, v6, v19
  v_dot2_f32_bf16 v19, v71, v7, v19
  v_dot2_f32_bf16 v20, v72, v4, 0
  v_dot2_f32_bf16 v20, v73, v5, v20
  v_dot2_f32_bf16 v20, v74, v6, v20
  v_dot2_f32_bf16 v20, v75, v7, v20
  v_dot2_f32_bf16 v21, v76, v4, 0
  v_dot2_f32_bf16 v21, v77, v5, v21
  v_dot2_f32_bf16 v21, v78, v6, v21
  v_dot2_f32_bf16 v21, v79, v7, v21
  v_add_f32_dpp v22, v18, v18 row_ror:8 row_mask:0xf bank_mask:0x3
  v_add_f32_dpp v23, v20, v20 row_ror:8 row_mask:0xf bank_mask:0x3
  s_nop 0
  v_add_f32_dpp v22, v19, v19 row_ror:8 row_mask:0xf bank_mask:0xc
  v_add_f32_dpp v23, v21, v21 row_ror:8 row_mask:0xf bank_mask:0xc
  s_nop 0
  v_add_f32_dpp v24, v22, v22 row_half_mirror row_mask:0xf bank_mask:0x5
  s_nop 1
  v_add_f32_dpp v24, v23, v23 row_half_mirror row_mask:0xf bank_mask:0xa
  s_nop 1
  v_add_f32_dpp v24, v24, v24 quad_perm:[1,0,3,2] row_mask:0xf bank_mask:0xf
  s_nop 1
  v_add_f32_dpp v24, v24, v24 quad_perm:[2,3,0,1] row_mask:0xf bank_mask:0xf
  v_max_f32 v250, v250, v24
  ds_write_b32 v251, v24 offset:0
  s_waitcnt vmcnt(4)
  s_xor_b32 s93, s87, 0x200700
  buffer_load_dwordx4 v[116:119], v253, s[32:35], s93 offen offset:0 nt
  v_dot2_f32_bf16 v18, v80, v4, 0
  v_dot2_f32_bf16 v18, v81, v5, v18
  v_dot2_f32_bf16 v18, v82, v6, v18
  v_dot2_f32_bf16 v18, v83, v7, v18
  v_dot2_f32_bf16 v19, v84, v4, 0
  v_dot2_f32_bf16 v19, v85, v5, v19
  v_dot2_f32_bf16 v19, v86, v6, v19
  v_dot2_f32_bf16 v19, v87, v7, v19
  v_dot2_f32_bf16 v20, v88, v4, 0
  v_dot2_f32_bf16 v20, v89, v5, v20
  v_dot2_f32_bf16 v20, v90, v6, v20
  v_dot2_f32_bf16 v20, v91, v7, v20
  s_waitcnt vmcnt(4)
  s_xor_b32 s93, s87, 0x240400
  buffer_load_dwordx4 v[120:123], v253, s[32:35], s93 offen offset:0 nt
  v_dot2_f32_bf16 v21, v92, v4, 0
  v_dot2_f32_bf16 v21, v93, v5, v21
  v_dot2_f32_bf16 v21, v94, v6, v21
  v_dot2_f32_bf16 v21, v95, v7, v21
  v_add_f32_dpp v22, v18, v18 row_ror:8 row_mask:0xf bank_mask:0x3
  v_add_f32_dpp v23, v20, v20 row_ror:8 row_mask:0xf bank_mask:0x3
  s_nop 0
  v_add_f32_dpp v22, v19, v19 row_ror:8 row_mask:0xf bank_mask:0xc
  v_add_f32_dpp v23, v21, v21 row_ror:8 row_mask:0xf bank_mask:0xc
  s_nop 0
  v_add_f32_dpp v24, v22, v22 row_half_mirror row_mask:0xf bank_mask:0x5
  s_nop 1
  v_add_f32_dpp v24, v23, v23 row_half_mirror row_mask:0xf bank_mask:0xa
  s_nop 1
  v_add_f32_dpp v24, v24, v24 quad_perm:[1,0,3,2] row_mask:0xf bank_mask:0xf
  s_nop 1
  v_add_f32_dpp v24, v24, v24 quad_perm:[2,3,0,1] row_mask:0xf bank_mask:0xf
  v_max_f32 v250, v250, v24
  ds_write_b32 v251, v24 offset:4
  v_add_u32 v251, 128, v251
  v_dot2_f32_bf16 v18, v96, v4, 0
  v_dot2_f32_bf16 v18, v97, v5, v18
  v_dot2_f32_bf16 v18, v98, v6, v18
  v_dot2_f32_bf16 v18, v99, v7, v18
  v_dot2_f32_bf16 v19, v100, v4, 0
  v_dot2_f32_bf16 v19, v101, v5, v19
  v_dot2_f32_bf16 v19, v102, v6, v19
  v_dot2_f32_bf16 v19, v103, v7, v19
  s_waitcnt vmcnt(4)
  s_xor_b32 s93, s87, 0x240700
  buffer_load_dwordx4 v[124:127], v253, s[32:35], s93 offen offset:0 nt
  v_dot2_f32_bf16 v20, v104, v4, 0
  v_dot2_f32_bf16 v20, v105, v5, v20
  v_dot2_f32_bf16 v20, v106, v6, v20
  v_dot2_f32_bf16 v20, v107, v7, v20
  s_waitcnt vmcnt(4)
  v_readlane_b32 s87, v243, 3
  s_nop 4
  buffer_load_dwordx4 v[32:35], v253, s[32:35], s87 offen offset:0 nt
  v_dot2_f32_bf16 v21, v108, v4, 0
  v_dot2_f32_bf16 v21, v109, v5, v21
  v_dot2_f32_bf16 v21, v110, v6, v21
  v_dot2_f32_bf16 v21, v111, v7, v21
  v_add_f32_dpp v22, v18, v18 row_ror:8 row_mask:0xf bank_mask:0x3
  v_add_f32_dpp v23, v20, v20 row_ror:8 row_mask:0xf bank_mask:0x3
  s_nop 0
  v_add_f32_dpp v22, v19, v19 row_ror:8 row_mask:0xf bank_mask:0xc
  v_add_f32_dpp v23, v21, v21 row_ror:8 row_mask:0xf bank_mask:0xc
  s_nop 0
  v_add_f32_dpp v24, v22, v22 row_half_mirror row_mask:0xf bank_mask:0x5
  s_nop 1
  v_add_f32_dpp v24, v23, v23 row_half_mirror row_mask:0xf bank_mask:0xa
  s_nop 1
  v_add_f32_dpp v24, v24, v24 quad_perm:[1,0,3,2] row_mask:0xf bank_mask:0xf
  s_nop 1
  v_add_f32_dpp v24, v24, v24 quad_perm:[2,3,0,1] row_mask:0xf bank_mask:0xf
  v_max_f32 v250, v250, v24
  ds_write_b32 v251, v24 offset:0
  s_waitcnt vmcnt(4)
  s_xor_b32 s93, s87, 0x300
  buffer_load_dwordx4 v[36:39], v253, s[32:35], s93 offen offset:0 nt
  v_dot2_f32_bf16 v18, v112, v4, 0
  v_dot2_f32_bf16 v18, v113, v5, v18
  v_dot2_f32_bf16 v18, v114, v6, v18
  v_dot2_f32_bf16 v18, v115, v7, v18
  s_waitcnt vmcnt(4)
  s_xor_b32 s93, s87, 0x40000
  buffer_load_dwordx4 v[40:43], v253, s[32:35], s93 offen offset:0 nt
  v_dot2_f32_bf16 v19, v116, v4, 0
  v_dot2_f32_bf16 v19, v117, v5, v19
  v_dot2_f32_bf16 v19, v118, v6, v19
  v_dot2_f32_bf16 v19, v119, v7, v19
  s_waitcnt vmcnt(4)
  s_xor_b32 s93, s87, 0x40300
  buffer_load_dwordx4 v[44:47], v253, s[32:35], s93 offen offset:0 nt
  v_dot2_f32_bf16 v20, v120, v4, 0
  v_dot2_f32_bf16 v20, v121, v5, v20
  v_dot2_f32_bf16 v20, v122, v6, v20
  v_dot2_f32_bf16 v20, v123, v7, v20
  s_waitcnt vmcnt(4)
  s_xor_b32 s93, s87, 0x200400
  buffer_load_dwordx4 v[48:51], v253, s[32:35], s93 offen offset:0 nt
  v_dot2_f32_bf16 v21, v124, v4, 0
  v_dot2_f32_bf16 v21, v125, v5, v21
  v_dot2_f32_bf16 v21, v126, v6, v21
  v_dot2_f32_bf16 v21, v127, v7, v21
  v_add_f32_dpp v22, v18, v18 row_ror:8 row_mask:0xf bank_mask:0x3
  v_add_f32_dpp v23, v20, v20 row_ror:8 row_mask:0xf bank_mask:0x3
  s_nop 0
  v_add_f32_dpp v22, v19, v19 row_ror:8 row_mask:0xf bank_mask:0xc
  v_add_f32_dpp v23, v21, v21 row_ror:8 row_mask:0xf bank_mask:0xc
  s_nop 0
  v_add_f32_dpp v24, v22, v22 row_half_mirror row_mask:0xf bank_mask:0x5
  s_nop 1
  v_add_f32_dpp v24, v23, v23 row_half_mirror row_mask:0xf bank_mask:0xa
  s_nop 1
  v_add_f32_dpp v24, v24, v24 quad_perm:[1,0,3,2] row_mask:0xf bank_mask:0xf
  s_nop 1
  v_add_f32_dpp v24, v24, v24 quad_perm:[2,3,0,1] row_mask:0xf bank_mask:0xf
  v_max_f32 v250, v250, v24
  ds_write_b32 v251, v24 offset:4
  v_add_u32 v251, 128, v251
L_loop:
  s_cmp_ge_u32 s100, s89
  s_cbranch_scc1 L_p1d
  v_readlane_b32 s25, v243, s100
  s_add_u32 s100, s100, 1
  s_waitcnt vmcnt(4)
  s_xor_b32 s93, s87, 0x200700
  buffer_load_dwordx4 v[52:55], v253, s[32:35], s93 offen offset:0 nt
  v_dot2_f32_bf16 v18, v32, v4, 0
  v_dot2_f32_bf16 v18, v33, v5, v18
  v_dot2_f32_bf16 v18, v34, v6, v18
  v_dot2_f32_bf16 v18, v35, v7, v18
  s_waitcnt vmcnt(4)
  s_xor_b32 s93, s87, 0x240400
  buffer_load_dwordx4 v[56:59], v253, s[32:35], s93 offen offset:0 nt
  v_dot2_f32_bf16 v19, v36, v4, 0
  v_dot2_f32_bf16 v19, v37, v5, v19
  v_dot2_f32_bf16 v19, v38, v6, v19
  v_dot2_f32_bf16 v19, v39, v7, v19
  s_waitcnt vmcnt(4)
  s_xor_b32 s93, s87, 0x240700
  buffer_load_dwordx4 v[60:63], v253, s[32:35], s93 offen offset:0 nt
  v_dot2_f32_bf16 v20, v40, v4, 0
  v_dot2_f32_bf16 v20, v41, v5, v20
  v_dot2_f32_bf16 v20, v42, v6, v20
  v_dot2_f32_bf16 v20, v43, v7, v20
  s_waitcnt vmcnt(4)
  buffer_load_dwordx4 v[32:35], v253, s[32:35], s25 offen offset:0 nt
  v_dot2_f32_bf16 v21, v44, v4, 0
  v_dot2_f32_bf16 v21, v45, v5, v21
  v_dot2_f32_bf16 v21, v46, v6, v21
  v_dot2_f32_bf16 v21, v47, v7, v21
  v_add_f32_dpp v22, v18, v18 row_ror:8 row_mask:0xf bank_mask:0x3
  v_add_f32_dpp v23, v20, v20 row_ror:8 row_mask:0xf bank_mask:0x3
  s_nop 0
  v_add_f32_dpp v22, v19, v19 row_ror:8 row_mask:0xf bank_mask:0xc
  v_add_f32_dpp v23, v21, v21 row_ror:8 row_mask:0xf bank_mask:0xc
  s_nop 0
  v_add_f32_dpp v24, v22, v22 row_half_mirror row_mask:0xf bank_mask:0x5
  s_nop 1
  v_add_f32_dpp v24, v23, v23 row_half_mirror row_mask:0xf bank_mask:0xa
  s_nop 1
  v_add_f32_dpp v24, v24, v24 quad_perm:[1,0,3,2] row_mask:0xf bank_mask:0xf
  s_nop 1
  v_add_f32_dpp v24, v24, v24 quad_perm:[2,3,0,1] row_mask:0xf bank_mask:0xf
  v_max_f32 v250, v250, v24
  ds_write_b32 v251, v24 offset:0
  s_waitcnt vmcnt(4)
  s_xor_b32 s93, s25, 0x300
  buffer_load_dwordx4 v[36:39], v253, s[32:35], s93 offen offset:0 nt
  s_xor_b32 s101, s25, 0x40000
  buffer_load_dwordx4 v[40:43], v253, s[32:35], s101 offen offset:0 nt
  v_dot2_f32_bf16 v18, v48, v4, 0
  v_dot2_f32_bf16 v18, v49, v5, v18
  v_dot2_f32_bf16 v18, v50, v6, v18
  v_dot2_f32_bf16 v18, v51, v7, v18
  s_waitcnt vmcnt(5)
  v_dot2_f32_bf16 v19, v52, v4, 0
  v_dot2_f32_bf16 v19, v53, v5, v19
  v_dot2_f32_bf16 v19, v54, v6, v19
  v_dot2_f32_bf16 v19, v55, v7, v19
  s_waitcnt vmcnt(4)
  s_xor_b32 s93, s25, 0x40300
  buffer_load_dwordx4 v[44:47], v253, s[32:35], s93 offen offset:0 nt
  v_dot2_f32_bf16 v20, v56, v4, 0
  v_dot2_f32_bf16 v20, v57, v5, v20
  v_dot2_f32_bf16 v20, v58, v6, v20
  v_dot2_f32_bf16 v20, v59, v7, v20
  s_waitcnt vmcnt(4)
  s_xor_b32 s93, s25, 0x200400
  buffer_load_dwordx4 v[48:51], v253, s[32:35], s93 offen offset:0 nt
  v_dot2_f32_bf16 v21, v60, v4, 0
  v_dot2_f32_bf16 v21, v61, v5, v21
  v_dot2_f32_bf16 v21, v62, v6, v21
  v_dot2_f32_bf16 v21, v63, v7, v21
  v_add_f32_dpp v22, v18, v18 row_ror:8 row_mask:0xf bank_mask:0x3
  v_add_f32_dpp v23, v20, v20 row_ror:8 row_mask:0xf bank_mask:0x3
  s_nop 0
  v_add_f32_dpp v22, v19, v19 row_ror:8 row_mask:0xf bank_mask:0xc
  v_add_f32_dpp v23, v21, v21 row_ror:8 row_mask:0xf bank_mask:0xc
  s_nop 0
  v_add_f32_dpp v24, v22, v22 row_half_mirror row_mask:0xf bank_mask:0x5
  s_nop 1
  v_add_f32_dpp v24, v23, v23 row_half_mirror row_mask:0xf bank_mask:0xa
  s_nop 1
  v_add_f32_dpp v24, v24, v24 quad_perm:[1,0,3,2] row_mask:0xf bank_mask:0xf
  s_nop 1
  v_add_f32_dpp v24, v24, v24 quad_perm:[2,3,0,1] row_mask:0xf bank_mask:0xf
  v_max_f32 v250, v250, v24
  ds_write_b32 v251, v24 offset:4
  v_add_u32 v251, 128, v251
  s_mov_b32 s87, s25
  s_branch L_loop
L_p1d:
  v_readlane_b32 s25, v243, 0
  s_mov_b32 s100, 1
  s_lshl_b32 s30, s3, 13
  s_mov_b32 s15, 0x20000
  s_cmp_eq_u32 s95, 1
  s_cselect_b32 s12, s56, s36
  s_cselect_b32 s13, s57, s37
  s_cselect_b32 s14, s58, s38
  s_cselect_b32 s23, 1, 0
  s_add_u32 s16, s30, 0
  s_xor_b32 s93, s25, 0x0
  s_cmp_eq_u32 s23, 1
  s_cselect_b32 s16, s16, s93
  s_add_u32 s17, s30, 1024
  s_xor_b32 s93, s25, 0x300
  s_cmp_eq_u32 s23, 1
  s_cselect_b32 s17, s17, s93
  s_add_u32 s18, s30, 2048
  s_xor_b32 s93, s25, 0x40000
  s_cmp_eq_u32 s23, 1
  s_cselect_b32 s18, s18, s93
  s_add_u32 s19, s30, 3072
  s_xor_b32 s93, s25, 0x40300
  s_cmp_eq_u32 s23, 1
  s_cselect_b32 s19, s19, s93
  s_add_u32 s20, s30, 4096
  s_xor_b32 s93, s25, 0x200400
  s_cmp_eq_u32 s23, 1
  s_cselect_b32 s20, s20, s93
  s_mov_b32 s25, s16
  s_cselect_b64 vcc, -1, 0
  v_cndmask_b32 v30, v253, v1, vcc
  s_waitcnt vmcnt(4)
  s_xor_b32 s93, s87, 0x200700
  buffer_load_dwordx4 v[52:55], v253, s[32:35], s93 offen offset:0 nt
  v_dot2_f32_bf16 v18, v32, v4, 0
  v_dot2_f32_bf16 v18, v33, v5, v18
  v_dot2_f32_bf16 v18, v34, v6, v18
  v_dot2_f32_bf16 v18, v35, v7, v18
  s_waitcnt vmcnt(4)
  s_xor_b32 s93, s87, 0x240400
  buffer_load_dwordx4 v[56:59], v253, s[32:35], s93 offen offset:0 nt
  v_dot2_f32_bf16 v19, v36, v4, 0
  v_dot2_f32_bf16 v19, v37, v5, v19
  v_dot2_f32_bf16 v19, v38, v6, v19
  v_dot2_f32_bf16 v19, v39, v7, v19
  s_waitcnt vmcnt(4)
  s_xor_b32 s93, s87, 0x240700
  buffer_load_dwordx4 v[60:63], v253, s[32:35], s93 offen offset:0 nt
  v_dot2_f32_bf16 v20, v40, v4, 0
  v_dot2_f32_bf16 v20, v41, v5, v20
  v_dot2_f32_bf16 v20, v42, v6, v20
  v_dot2_f32_bf16 v20, v43, v7, v20
  s_waitcnt vmcnt(4)
  v_xor_b32 v27, s16, v30
  buffer_load_dwordx4 v[32:35], v27, s[12:15], 0 offen offset:0 nt
  v_dot2_f32_bf16 v21, v44, v4, 0
  v_dot2_f32_bf16 v21, v45, v5, v21
  v_dot2_f32_bf16 v21, v46, v6, v21
  v_dot2_f32_bf16 v21, v47, v7, v21
  v_add_f32_dpp v22, v18, v18 row_ror:8 row_mask:0xf bank_mask:0x3
  v_add_f32_dpp v23, v20, v20 row_ror:8 row_mask:0xf bank_mask:0x3
  s_nop 0
  v_add_f32_dpp v22, v19, v19 row_ror:8 row_mask:0xf bank_mask:0xc
  v_add_f32_dpp v23, v21, v21 row_ror:8 row_mask:0xf bank_mask:0xc
  s_nop 0
  v_add_f32_dpp v24, v22, v22 row_half_mirror row_mask:0xf bank_mask:0x5
  s_nop 1
  v_add_f32_dpp v24, v23, v23 row_half_mirror row_mask:0xf bank_mask:0xa
  s_nop 1
  v_add_f32_dpp v24, v24, v24 quad_perm:[1,0,3,2] row_mask:0xf bank_mask:0xf
  s_nop 1
  v_add_f32_dpp v24, v24, v24 quad_perm:[2,3,0,1] row_mask:0xf bank_mask:0xf
  v_max_f32 v250, v250, v24
  ds_write_b32 v251, v24 offset:0
  s_waitcnt vmcnt(4)
  v_xor_b32 v27, s17, v30
  buffer_load_dwordx4 v[36:39], v27, s[12:15], 0 offen offset:0 nt
  v_xor_b32 v25, s18, v30
  buffer_load_dwordx4 v[40:43], v25, s[12:15], 0 offen offset:0 nt
  v_dot2_f32_bf16 v18, v48, v4, 0
  v_dot2_f32_bf16 v18, v49, v5, v18
  v_dot2_f32_bf16 v18, v50, v6, v18
  v_dot2_f32_bf16 v18, v51, v7, v18
  s_waitcnt vmcnt(5)
  v_dot2_f32_bf16 v19, v52, v4, 0
  v_dot2_f32_bf16 v19, v53, v5, v19
  v_dot2_f32_bf16 v19, v54, v6, v19
  v_dot2_f32_bf16 v19, v55, v7, v19
  s_waitcnt vmcnt(4)
  v_xor_b32 v27, s19, v30
  buffer_load_dwordx4 v[44:47], v27, s[12:15], 0 offen offset:0 nt
  v_dot2_f32_bf16 v20, v56, v4, 0
  v_dot2_f32_bf16 v20, v57, v5, v20
  v_dot2_f32_bf16 v20, v58, v6, v20
  v_dot2_f32_bf16 v20, v59, v7, v20
  s_waitcnt vmcnt(4)
  v_xor_b32 v27, s20, v30
  buffer_load_dwordx4 v[48:51], v27, s[12:15], 0 offen offset:0 nt
  v_dot2_f32_bf16 v21, v60, v4, 0
  v_dot2_f32_bf16 v21, v61, v5, v21
  v_dot2_f32_bf16 v21, v62, v6, v21
  v_dot2_f32_bf16 v21, v63, v7, v21
  v_add_f32_dpp v22, v18, v18 row_ror:8 row_mask:0xf bank_mask:0x3
  v_add_f32_dpp v23, v20, v20 row_ror:8 row_mask:0xf bank_mask:0x3
  s_nop 0
  v_add_f32_dpp v22, v19, v19 row_ror:8 row_mask:0xf bank_mask:0xc
  v_add_f32_dpp v23, v21, v21 row_ror:8 row_mask:0xf bank_mask:0xc
  s_nop 0
  v_add_f32_dpp v24, v22, v22 row_half_mirror row_mask:0xf bank_mask:0x5
  s_nop 1
  v_add_f32_dpp v24, v23, v23 row_half_mirror row_mask:0xf bank_mask:0xa
  s_nop 1
  v_add_f32_dpp v24, v24, v24 quad_perm:[1,0,3,2] row_mask:0xf bank_mask:0xf
  s_nop 1
  v_add_f32_dpp v24, v24, v24 quad_perm:[2,3,0,1] row_mask:0xf bank_mask:0xf
  v_max_f32 v250, v250, v24
  ds_write_b32 v251, v24 offset:4
  v_add_u32 v251, 128, v251
  s_mov_b32 s87, s25
  v_max_f32_dpp v250, v250, v250 row_ror:4 row_mask:0xf bank_mask:0xf
  s_lshl_b32 s91, s3, 13
  s_add_u32 s91, s91, 32768
  v_lshrrev_b32 v251, 2, v0
  v_lshl_add_u32 v251, v251, 3, s91
  v_max_f32_dpp v250, v250, v250 row_ror:8 row_mask:0xf bank_mask:0xf
  v_mul_f32 v16, s92, v250
  s_cmp_eq_u32 s95, 1
  s_cbranch_scc1 L_event
L_p2:
  ds_read_b64 v[18:19], v251
  v_add_u32 v251, 128, v251
  s_cmp_ge_u32 s100, s89
  s_cbranch_scc1 L_p2last
  v_readlane_b32 s25, v243, s100
  s_add_u32 s100, s100, 1
  s_waitcnt vmcnt(4)
  s_xor_b32 s93, s87, 0x200700
  buffer_load_dwordx4 v[52:55], v253, s[36:39], s93 offen offset:0 nt
  s_xor_b32 s101, s87, 0x240400
  buffer_load_dwordx4 v[56:59], v253, s[36:39], s101 offen offset:0 nt
  s_waitcnt lgkmcnt(0)
  v_fma_f32 v18, v18, s92, -v16
  v_fma_f32 v19, v19, s92, -v16
  v_exp_f32 v18, v18
  v_exp_f32 v19, v19
  v_cvt_pk_bf16_f32 v28, v18, 0
  v_add_f32 v17, v17, v18
  v_cvt_pk_bf16_f32 v20, v19, 0
  v_lshlrev_b32 v29, 16, v28
  v_add_f32 v17, v17, v19
  v_lshlrev_b32 v21, 16, v20
  v_dot2c_f32_bf16_dpp v8, v28, v32 row_newbcast:0 row_mask:0xf bank_mask:0xf
  v_dot2c_f32_bf16_dpp v9, v29, v32 row_newbcast:0 row_mask:0xf bank_mask:0xf
  v_dot2c_f32_bf16_dpp v10, v28, v33 row_newbcast:0 row_mask:0xf bank_mask:0xf
  v_dot2c_f32_bf16_dpp v11, v29, v33 row_newbcast:0 row_mask:0xf bank_mask:0xf
  v_dot2c_f32_bf16_dpp v12, v28, v34 row_newbcast:0 row_mask:0xf bank_mask:0xf
  v_dot2c_f32_bf16_dpp v13, v29, v34 row_newbcast:0 row_mask:0xf bank_mask:0xf
  v_dot2c_f32_bf16_dpp v14, v28, v35 row_newbcast:0 row_mask:0xf bank_mask:0xf
  v_dot2c_f32_bf16_dpp v15, v29, v35 row_newbcast:0 row_mask:0xf bank_mask:0xf
  s_waitcnt vmcnt(5)
  s_xor_b32 s93, s87, 0x240700
  buffer_load_dwordx4 v[60:63], v253, s[36:39], s93 offen offset:0 nt
  v_dot2c_f32_bf16_dpp v8, v28, v36 row_newbcast:8 row_mask:0xf bank_mask:0xf
  v_dot2c_f32_bf16_dpp v9, v29, v36 row_newbcast:8 row_mask:0xf bank_mask:0xf
  v_dot2c_f32_bf16_dpp v10, v28, v37 row_newbcast:8 row_mask:0xf bank_mask:0xf
  v_dot2c_f32_bf16_dpp v11, v29, v37 row_newbcast:8 row_mask:0xf bank_mask:0xf
  v_dot2c_f32_bf16_dpp v12, v28, v38 row_newbcast:8 row_mask:0xf bank_mask:0xf
  v_dot2c_f32_bf16_dpp v13, v29, v38 row_newbcast:8 row_mask:0xf bank_mask:0xf
  v_dot2c_f32_bf16_dpp v14, v28, v39 row_newbcast:8 row_mask:0xf bank_mask:0xf
  v_dot2c_f32_bf16_dpp v15, v29, v39 row_newbcast:8 row_mask:0xf bank_mask:0xf
  s_waitcnt vmcnt(5)
  v_dot2c_f32_bf16_dpp v8, v28, v40 row_newbcast:4 row_mask:0xf bank_mask:0xf
  v_dot2c_f32_bf16_dpp v9, v29, v40 row_newbcast:4 row_mask:0xf bank_mask:0xf
  v_dot2c_f32_bf16_dpp v10, v28, v41 row_newbcast:4 row_mask:0xf bank_mask:0xf
  v_dot2c_f32_bf16_dpp v11, v29, v41 row_newbcast:4 row_mask:0xf bank_mask:0xf
  v_dot2c_f32_bf16_dpp v12, v28, v42 row_newbcast:4 row_mask:0xf bank_mask:0xf
  v_dot2c_f32_bf16_dpp v13, v29, v42 row_newbcast:4 row_mask:0xf bank_mask:0xf
  v_dot2c_f32_bf16_dpp v14, v28, v43 row_newbcast:4 row_mask:0xf bank_mask:0xf
  v_dot2c_f32_bf16_dpp v15, v29, v43 row_newbcast:4 row_mask:0xf bank_mask:0xf
  s_waitcnt vmcnt(4)
  buffer_load_dwordx4 v[32:35], v253, s[36:39], s25 offen offset:0 nt
  v_dot2c_f32_bf16_dpp v8, v28, v44 row_newbcast:12 row_mask:0xf bank_mask:0xf
  v_dot2c_f32_bf16_dpp v9, v29, v44 row_newbcast:12 row_mask:0xf bank_mask:0xf
  v_dot2c_f32_bf16_dpp v10, v28, v45 row_newbcast:12 row_mask:0xf bank_mask:0xf
  v_dot2c_f32_bf16_dpp v11, v29, v45 row_newbcast:12 row_mask:0xf bank_mask:0xf
  v_dot2c_f32_bf16_dpp v12, v28, v46 row_newbcast:12 row_mask:0xf bank_mask:0xf
  v_dot2c_f32_bf16_dpp v13, v29, v46 row_newbcast:12 row_mask:0xf bank_mask:0xf
  v_dot2c_f32_bf16_dpp v14, v28, v47 row_newbcast:12 row_mask:0xf bank_mask:0xf
  v_dot2c_f32_bf16_dpp v15, v29, v47 row_newbcast:12 row_mask:0xf bank_mask:0xf
  s_waitcnt vmcnt(4)
  s_xor_b32 s93, s25, 0x300
  buffer_load_dwordx4 v[36:39], v253, s[36:39], s93 offen offset:0 nt
  v_dot2c_f32_bf16_dpp v8, v20, v48 row_newbcast:0 row_mask:0xf bank_mask:0xf
  v_dot2c_f32_bf16_dpp v9, v21, v48 row_newbcast:0 row_mask:0xf bank_mask:0xf
  v_dot2c_f32_bf16_dpp v10, v20, v49 row_newbcast:0 row_mask:0xf bank_mask:0xf
  v_dot2c_f32_bf16_dpp v11, v21, v49 row_newbcast:0 row_mask:0xf bank_mask:0xf
  v_dot2c_f32_bf16_dpp v12, v20, v50 row_newbcast:0 row_mask:0xf bank_mask:0xf
  v_dot2c_f32_bf16_dpp v13, v21, v50 row_newbcast:0 row_mask:0xf bank_mask:0xf
  v_dot2c_f32_bf16_dpp v14, v20, v51 row_newbcast:0 row_mask:0xf bank_mask:0xf
  v_dot2c_f32_bf16_dpp v15, v21, v51 row_newbcast:0 row_mask:0xf bank_mask:0xf
  s_waitcnt vmcnt(4)
  s_xor_b32 s93, s25, 0x40000
  buffer_load_dwordx4 v[40:43], v253, s[36:39], s93 offen offset:0 nt
  v_dot2c_f32_bf16_dpp v8, v20, v52 row_newbcast:8 row_mask:0xf bank_mask:0xf
  v_dot2c_f32_bf16_dpp v9, v21, v52 row_newbcast:8 row_mask:0xf bank_mask:0xf
  v_dot2c_f32_bf16_dpp v10, v20, v53 row_newbcast:8 row_mask:0xf bank_mask:0xf
  v_dot2c_f32_bf16_dpp v11, v21, v53 row_newbcast:8 row_mask:0xf bank_mask:0xf
  v_dot2c_f32_bf16_dpp v12, v20, v54 row_newbcast:8 row_mask:0xf bank_mask:0xf
  v_dot2c_f32_bf16_dpp v13, v21, v54 row_newbcast:8 row_mask:0xf bank_mask:0xf
  v_dot2c_f32_bf16_dpp v14, v20, v55 row_newbcast:8 row_mask:0xf bank_mask:0xf
  v_dot2c_f32_bf16_dpp v15, v21, v55 row_newbcast:8 row_mask:0xf bank_mask:0xf
  s_waitcnt vmcnt(4)
  s_xor_b32 s93, s25, 0x40300
  buffer_load_dwordx4 v[44:47], v253, s[36:39], s93 offen offset:0 nt
  v_dot2c_f32_bf16_dpp v8, v20, v56 row_newbcast:4 row_mask:0xf bank_mask:0xf
  v_dot2c_f32_bf16_dpp v9, v21, v56 row_newbcast:4 row_mask:0xf bank_mask:0xf
  v_dot2c_f32_bf16_dpp v10, v20, v57 row_newbcast:4 row_mask:0xf bank_mask:0xf
  v_dot2c_f32_bf16_dpp v11, v21, v57 row_newbcast:4 row_mask:0xf bank_mask:0xf
  v_dot2c_f32_bf16_dpp v12, v20, v58 row_newbcast:4 row_mask:0xf bank_mask:0xf
  v_dot2c_f32_bf16_dpp v13, v21, v58 row_newbcast:4 row_mask:0xf bank_mask:0xf
  v_dot2c_f32_bf16_dpp v14, v20, v59 row_newbcast:4 row_mask:0xf bank_mask:0xf
  v_dot2c_f32_bf16_dpp v15, v21, v59 row_newbcast:4 row_mask:0xf bank_mask:0xf
  s_waitcnt vmcnt(4)
  s_xor_b32 s93, s25, 0x200400
  buffer_load_dwordx4 v[48:51], v253, s[36:39], s93 offen offset:0 nt
  v_dot2c_f32_bf16_dpp v8, v20, v60 row_newbcast:12 row_mask:0xf bank_mask:0xf
  v_dot2c_f32_bf16_dpp v9, v21, v60 row_newbcast:12 row_mask:0xf bank_mask:0xf
  v_dot2c_f32_bf16_dpp v10, v20, v61 row_newbcast:12 row_mask:0xf bank_mask:0xf
  v_dot2c_f32_bf16_dpp v11, v21, v61 row_newbcast:12 row_mask:0xf bank_mask:0xf
  v_dot2c_f32_bf16_dpp v12, v20, v62 row_newbcast:12 row_mask:0xf bank_mask:0xf
  v_dot2c_f32_bf16_dpp v13, v21, v62 row_newbcast:12 row_mask:0xf bank_mask:0xf
  v_dot2c_f32_bf16_dpp v14, v20, v63 row_newbcast:12 row_mask:0xf bank_mask:0xf
  v_dot2c_f32_bf16_dpp v15, v21, v63 row_newbcast:12 row_mask:0xf bank_mask:0xf
  s_mov_b32 s87, s25
  s_branch L_p2
L_p2last:
  s_waitcnt lgkmcnt(0)
  s_mov_b32 s88, 1
  s_atomic_add s88, s[82:83], 128 glc
  v_fma_f32 v18, v18, s92, -v16
  v_fma_f32 v19, v19, s92, -v16
  v_exp_f32 v18, v18
  v_exp_f32 v19, v19
  v_cvt_pk_bf16_f32 v28, v18, 0
  v_add_f32 v17, v17, v18
  v_cvt_pk_bf16_f32 v20, v19, 0
  v_lshlrev_b32 v29, 16, v28
  v_add_f32 v17, v17, v19
  v_lshlrev_b32 v21, 16, v20
  s_waitcnt vmcnt(4)
  s_xor_b32 s93, s87, 0x200700
  buffer_load_dwordx4 v[52:55], v253, s[36:39], s93 offen offset:0 nt
  v_dot2c_f32_bf16_dpp v8, v28, v32 row_newbcast:0 row_mask:0xf bank_mask:0xf
  v_dot2c_f32_bf16_dpp v9, v29, v32 row_newbcast:0 row_mask:0xf bank_mask:0xf
  v_dot2c_f32_bf16_dpp v10, v28, v33 row_newbcast:0 row_mask:0xf bank_mask:0xf
  v_dot2c_f32_bf16_dpp v11, v29, v33 row_newbcast:0 row_mask:0xf bank_mask:0xf
  v_dot2c_f32_bf16_dpp v12, v28, v34 row_newbcast:0 row_mask:0xf bank_mask:0xf
  v_dot2c_f32_bf16_dpp v13, v29, v34 row_newbcast:0 row_mask:0xf bank_mask:0xf
  v_dot2c_f32_bf16_dpp v14, v28, v35 row_newbcast:0 row_mask:0xf bank_mask:0xf
  v_dot2c_f32_bf16_dpp v15, v29, v35 row_newbcast:0 row_mask:0xf bank_mask:0xf
  s_waitcnt vmcnt(4)
  s_xor_b32 s93, s87, 0x240400
  buffer_load_dwordx4 v[56:59], v253, s[36:39], s93 offen offset:0 nt
  v_dot2c_f32_bf16_dpp v8, v28, v36 row_newbcast:8 row_mask:0xf bank_mask:0xf
  v_dot2c_f32_bf16_dpp v9, v29, v36 row_newbcast:8 row_mask:0xf bank_mask:0xf
  v_dot2c_f32_bf16_dpp v10, v28, v37 row_newbcast:8 row_mask:0xf bank_mask:0xf
  v_dot2c_f32_bf16_dpp v11, v29, v37 row_newbcast:8 row_mask:0xf bank_mask:0xf
  v_dot2c_f32_bf16_dpp v12, v28, v38 row_newbcast:8 row_mask:0xf bank_mask:0xf
  v_dot2c_f32_bf16_dpp v13, v29, v38 row_newbcast:8 row_mask:0xf bank_mask:0xf
  v_dot2c_f32_bf16_dpp v14, v28, v39 row_newbcast:8 row_mask:0xf bank_mask:0xf
  v_dot2c_f32_bf16_dpp v15, v29, v39 row_newbcast:8 row_mask:0xf bank_mask:0xf
  s_waitcnt vmcnt(4)
  s_xor_b32 s93, s87, 0x240700
  buffer_load_dwordx4 v[60:63], v253, s[36:39], s93 offen offset:0 nt
  v_dot2c_f32_bf16_dpp v8, v28, v40 row_newbcast:4 row_mask:0xf bank_mask:0xf
  v_dot2c_f32_bf16_dpp v9, v29, v40 row_newbcast:4 row_mask:0xf bank_mask:0xf
  v_dot2c_f32_bf16_dpp v10, v28, v41 row_newbcast:4 row_mask:0xf bank_mask:0xf
  v_dot2c_f32_bf16_dpp v11, v29, v41 row_newbcast:4 row_mask:0xf bank_mask:0xf
  v_dot2c_f32_bf16_dpp v12, v28, v42 row_newbcast:4 row_mask:0xf bank_mask:0xf
  v_dot2c_f32_bf16_dpp v13, v29, v42 row_newbcast:4 row_mask:0xf bank_mask:0xf
  v_dot2c_f32_bf16_dpp v14, v28, v43 row_newbcast:4 row_mask:0xf bank_mask:0xf
  v_dot2c_f32_bf16_dpp v15, v29, v43 row_newbcast:4 row_mask:0xf bank_mask:0xf
  s_waitcnt vmcnt(4)
  s_waitcnt lgkmcnt(0)
  s_add_u32 s91, s88, 1
  s_cmp_ge_u32 s91, 112
  s_cbranch_scc1 L_tail0
  s_lshr_b32 s31, s91, 1
  v_readlane_b32 s25, v254, s31
  s_bitcmp1_b32 s91, 0
  s_cselect_b32 s31, 0x200400, 0
  s_xor_b32 s25, s25, s31
  s_cmp_ge_u32 s91, 88
  s_cbranch_scc1 L_tail0_f
  buffer_load_dwordx4 v[32:35], v253, s[32:35], s25 offen offset:0 nt
  v_dot2c_f32_bf16_dpp v8, v28, v44 row_newbcast:12 row_mask:0xf bank_mask:0xf
  v_dot2c_f32_bf16_dpp v9, v29, v44 row_newbcast:12 row_mask:0xf bank_mask:0xf
  v_dot2c_f32_bf16_dpp v10, v28, v45 row_newbcast:12 row_mask:0xf bank_mask:0xf
  v_dot2c_f32_bf16_dpp v11, v29, v45 row_newbcast:12 row_mask:0xf bank_mask:0xf
  v_dot2c_f32_bf16_dpp v12, v28, v46 row_newbcast:12 row_mask:0xf bank_mask:0xf
  v_dot2c_f32_bf16_dpp v13, v29, v46 row_newbcast:12 row_mask:0xf bank_mask:0xf
  v_dot2c_f32_bf16_dpp v14, v28, v47 row_newbcast:12 row_mask:0xf bank_mask:0xf
  v_dot2c_f32_bf16_dpp v15, v29, v47 row_newbcast:12 row_mask:0xf bank_mask:0xf
  s_waitcnt vmcnt(4)
  s_xor_b32 s93, s25, 0x300
  buffer_load_dwordx4 v[36:39], v253, s[32:35], s93 offen offset:0 nt
  s_xor_b32 s101, s25, 0x40000
  buffer_load_dwordx4 v[40:43], v253, s[32:35], s101 offen offset:0 nt
  v_dot2c_f32_bf16_dpp v8, v20, v48 row_newbcast:0 row_mask:0xf bank_mask:0xf
  v_dot2c_f32_bf16_dpp v9, v21, v48 row_newbcast:0 row_mask:0xf bank_mask:0xf
  v_dot2c_f32_bf16_dpp v10, v20, v49 row_newbcast:0 row_mask:0xf bank_mask:0xf
  v_dot2c_f32_bf16_dpp v11, v21, v49 row_newbcast:0 row_mask:0xf bank_mask:0xf
  v_dot2c_f32_bf16_dpp v12, v20, v50 row_newbcast:0 row_mask:0xf bank_mask:0xf
  v_dot2c_f32_bf16_dpp v13, v21, v50 row_newbcast:0 row_mask:0xf bank_mask:0xf
  v_dot2c_f32_bf16_dpp v14, v20, v51 row_newbcast:0 row_mask:0xf bank_mask:0xf
  v_dot2c_f32_bf16_dpp v15, v21, v51 row_newbcast:0 row_mask:0xf bank_mask:0xf
  s_waitcnt vmcnt(5)
  v_dot2c_f32_bf16_dpp v8, v20, v52 row_newbcast:8 row_mask:0xf bank_mask:0xf
  v_dot2c_f32_bf16_dpp v9, v21, v52 row_newbcast:8 row_mask:0xf bank_mask:0xf
  v_dot2c_f32_bf16_dpp v10, v20, v53 row_newbcast:8 row_mask:0xf bank_mask:0xf
  v_dot2c_f32_bf16_dpp v11, v21, v53 row_newbcast:8 row_mask:0xf bank_mask:0xf
  v_dot2c_f32_bf16_dpp v12, v20, v54 row_newbcast:8 row_mask:0xf bank_mask:0xf
  v_dot2c_f32_bf16_dpp v13, v21, v54 row_newbcast:8 row_mask:0xf bank_mask:0xf
  v_dot2c_f32_bf16_dpp v14, v20, v55 row_newbcast:8 row_mask:0xf bank_mask:0xf
  v_dot2c_f32_bf16_dpp v15, v21, v55 row_newbcast:8 row_mask:0xf bank_mask:0xf
  s_waitcnt vmcnt(4)
  s_xor_b32 s93, s25, 0x40300
  buffer_load_dwordx4 v[44:47], v253, s[32:35], s93 offen offset:0 nt
  v_dot2c_f32_bf16_dpp v8, v20, v56 row_newbcast:4 row_mask:0xf bank_mask:0xf
  v_dot2c_f32_bf16_dpp v9, v21, v56 row_newbcast:4 row_mask:0xf bank_mask:0xf
  v_dot2c_f32_bf16_dpp v10, v20, v57 row_newbcast:4 row_mask:0xf bank_mask:0xf
  v_dot2c_f32_bf16_dpp v11, v21, v57 row_newbcast:4 row_mask:0xf bank_mask:0xf
  v_dot2c_f32_bf16_dpp v12, v20, v58 row_newbcast:4 row_mask:0xf bank_mask:0xf
  v_dot2c_f32_bf16_dpp v13, v21, v58 row_newbcast:4 row_mask:0xf bank_mask:0xf
  v_dot2c_f32_bf16_dpp v14, v20, v59 row_newbcast:4 row_mask:0xf bank_mask:0xf
  v_dot2c_f32_bf16_dpp v15, v21, v59 row_newbcast:4 row_mask:0xf bank_mask:0xf
  s_waitcnt vmcnt(4)
  buffer_load_dwordx4 v[48:51], v253, s[36:39], s25 offen offset:0 nt
  v_dot2c_f32_bf16_dpp v8, v20, v60 row_newbcast:12 row_mask:0xf bank_mask:0xf
  v_dot2c_f32_bf16_dpp v9, v21, v60 row_newbcast:12 row_mask:0xf bank_mask:0xf
  v_dot2c_f32_bf16_dpp v10, v20, v61 row_newbcast:12 row_mask:0xf bank_mask:0xf
  v_dot2c_f32_bf16_dpp v11, v21, v61 row_newbcast:12 row_mask:0xf bank_mask:0xf
  v_dot2c_f32_bf16_dpp v12, v20, v62 row_newbcast:12 row_mask:0xf bank_mask:0xf
  v_dot2c_f32_bf16_dpp v13, v21, v62 row_newbcast:12 row_mask:0xf bank_mask:0xf
  v_dot2c_f32_bf16_dpp v14, v20, v63 row_newbcast:12 row_mask:0xf bank_mask:0xf
  v_dot2c_f32_bf16_dpp v15, v21, v63 row_newbcast:12 row_mask:0xf bank_mask:0xf
  s_mov_b32 s87, s25
L_loop3:
  s_mov_b32 s88, 1
  s_atomic_add s88, s[82:83], 128 glc
  s_waitcnt vmcnt(4)
  s_xor_b32 s93, s87, 0x300
  buffer_load_dwordx4 v[52:55], v253, s[36:39], s93 offen offset:0 nt
  v_dot2_f32_bf16 v18, v32, v4, 0
  v_dot2_f32_bf16 v18, v33, v5, v18
  v_dot2_f32_bf16 v18, v34, v6, v18
  v_dot2_f32_bf16 v18, v35, v7, v18
  s_waitcnt vmcnt(4)
  s_xor_b32 s93, s87, 0x40000
  buffer_load_dwordx4 v[56:59], v253, s[36:39], s93 offen offset:0 nt
  v_dot2_f32_bf16 v19, v36, v4, 0
  v_dot2_f32_bf16 v19, v37, v5, v19
  v_dot2_f32_bf16 v19, v38, v6, v19
  v_dot2_f32_bf16 v19, v39, v7, v19
  s_waitcnt vmcnt(4)
  s_xor_b32 s93, s87, 0x40300
  buffer_load_dwordx4 v[60:63], v253, s[36:39], s93 offen offset:0 nt
  v_dot2_f32_bf16 v20, v40, v4, 0
  v_dot2_f32_bf16 v20, v41, v5, v20
  v_dot2_f32_bf16 v20, v42, v6, v20
  v_dot2_f32_bf16 v20, v43, v7, v20
  s_waitcnt vmcnt(4)
  s_waitcnt lgkmcnt(0)
  s_add_u32 s91, s88, 1
  s_cmp_ge_u32 s91, 112
  s_cbranch_scc1 L_drain
  s_lshr_b32 s31, s91, 1
  v_readlane_b32 s25, v254, s31
  s_bitcmp1_b32 s91, 0
  s_cselect_b32 s31, 0x200400, 0
  s_xor_b32 s25, s25, s31
  s_cmp_ge_u32 s91, 88
  s_cbranch_scc1 L_drain_f
  buffer_load_dwordx4 v[32:35], v253, s[32:35], s25 offen offset:0 nt
  v_dot2_f32_bf16 v21, v44, v4, 0
  v_dot2_f32_bf16 v21, v45, v5, v21
  v_dot2_f32_bf16 v21, v46, v6, v21
  v_dot2_f32_bf16 v21, v47, v7, v21
  v_add_f32_dpp v22, v18, v18 row_ror:8 row_mask:0xf bank_mask:0x3
  v_add_f32_dpp v23, v20, v20 row_ror:8 row_mask:0xf bank_mask:0x3
  s_nop 0
  v_add_f32_dpp v22, v19, v19 row_ror:8 row_mask:0xf bank_mask:0xc
  v_add_f32_dpp v23, v21, v21 row_ror:8 row_mask:0xf bank_mask:0xc
  s_nop 0
  v_add_f32_dpp v24, v22, v22 row_half_mirror row_mask:0xf bank_mask:0x5
  s_nop 1
  v_add_f32_dpp v24, v23, v23 row_half_mirror row_mask:0xf bank_mask:0xa
  s_nop 1
  v_add_f32_dpp v24, v24, v24 quad_perm:[1,0,3,2] row_mask:0xf bank_mask:0xf
  s_nop 1
  v_add_f32_dpp v24, v24, v24 quad_perm:[2,3,0,1] row_mask:0xf bank_mask:0xf
  s_nop 1
  v_max_f32_dpp v25, v24, v24 row_ror:4 row_mask:0xf bank_mask:0xf
  s_nop 1
  v_max_f32_dpp v25, v25, v25 row_ror:8 row_mask:0xf bank_mask:0xf
  v_mul_f32 v25, s92, v25
  v_max_f32 v30, v16, v25
  v_fma_f32 v24, v24, s92, -v30
  v_sub_f32 v26, v16, v30
  v_exp_f32 v24, v24
  v_exp_f32 v26, v26
  v_mov_b32 v16, v30
  v_cvt_pk_bf16_f32 v28, v24, 0
  v_fma_f32 v17, v17, v26, v24
  v_lshlrev_b32 v29, 16, v28
  v_pk_mul_f32 v[8:9], v[8:9], v[26:27] op_sel_hi:[1,0]
  v_pk_mul_f32 v[10:11], v[10:11], v[26:27] op_sel_hi:[1,0]
  v_pk_mul_f32 v[12:13], v[12:13], v[26:27] op_sel_hi:[1,0]
  v_pk_mul_f32 v[14:15], v[14:15], v[26:27] op_sel_hi:[1,0]
  s_waitcnt vmcnt(4)
  s_xor_b32 s93, s25, 0x300
  buffer_load_dwordx4 v[36:39], v253, s[32:35], s93 offen offset:0 nt
  s_xor_b32 s101, s25, 0x40000
  buffer_load_dwordx4 v[40:43], v253, s[32:35], s101 offen offset:0 nt
  v_dot2c_f32_bf16_dpp v8, v28, v48 row_newbcast:0 row_mask:0xf bank_mask:0xf
  v_dot2c_f32_bf16_dpp v9, v29, v48 row_newbcast:0 row_mask:0xf bank_mask:0xf
  v_dot2c_f32_bf16_dpp v10, v28, v49 row_newbcast:0 row_mask:0xf bank_mask:0xf
  v_dot2c_f32_bf16_dpp v11, v29, v49 row_newbcast:0 row_mask:0xf bank_mask:0xf
  v_dot2c_f32_bf16_dpp v12, v28, v50 row_newbcast:0 row_mask:0xf bank_mask:0xf
  v_dot2c_f32_bf16_dpp v13, v29, v50 row_newbcast:0 row_mask:0xf bank_mask:0xf
  v_dot2c_f32_bf16_dpp v14, v28, v51 row_newbcast:0 row_mask:0xf bank_mask:0xf
  v_dot2c_f32_bf16_dpp v15, v29, v51 row_newbcast:0 row_mask:0xf bank_mask:0xf
  s_waitcnt vmcnt(5)
  v_dot2c_f32_bf16_dpp v8, v28, v52 row_newbcast:8 row_mask:0xf bank_mask:0xf
  v_dot2c_f32_bf16_dpp v9, v29, v52 row_newbcast:8 row_mask:0xf bank_mask:0xf
  v_dot2c_f32_bf16_dpp v10, v28, v53 row_newbcast:8 row_mask:0xf bank_mask:0xf
  v_dot2c_f32_bf16_dpp v11, v29, v53 row_newbcast:8 row_mask:0xf bank_mask:0xf
  v_dot2c_f32_bf16_dpp v12, v28, v54 row_newbcast:8 row_mask:0xf bank_mask:0xf
  v_dot2c_f32_bf16_dpp v13, v29, v54 row_newbcast:8 row_mask:0xf bank_mask:0xf
  v_dot2c_f32_bf16_dpp v14, v28, v55 row_newbcast:8 row_mask:0xf bank_mask:0xf
  v_dot2c_f32_bf16_dpp v15, v29, v55 row_newbcast:8 row_mask:0xf bank_mask:0xf
  s_waitcnt vmcnt(4)
  s_xor_b32 s93, s25, 0x40300
  buffer_load_dwordx4 v[44:47], v253, s[32:35], s93 offen offset:0 nt
  v_dot2c_f32_bf16_dpp v8, v28, v56 row_newbcast:4 row_mask:0xf bank_mask:0xf
  v_dot2c_f32_bf16_dpp v9, v29, v56 row_newbcast:4 row_mask:0xf bank_mask:0xf
  v_dot2c_f32_bf16_dpp v10, v28, v57 row_newbcast:4 row_mask:0xf bank_mask:0xf
  v_dot2c_f32_bf16_dpp v11, v29, v57 row_newbcast:4 row_mask:0xf bank_mask:0xf
  v_dot2c_f32_bf16_dpp v12, v28, v58 row_newbcast:4 row_mask:0xf bank_mask:0xf
  v_dot2c_f32_bf16_dpp v13, v29, v58 row_newbcast:4 row_mask:0xf bank_mask:0xf
  v_dot2c_f32_bf16_dpp v14, v28, v59 row_newbcast:4 row_mask:0xf bank_mask:0xf
  v_dot2c_f32_bf16_dpp v15, v29, v59 row_newbcast:4 row_mask:0xf bank_mask:0xf
  s_waitcnt vmcnt(4)
  buffer_load_dwordx4 v[48:51], v253, s[36:39], s25 offen offset:0 nt
  v_dot2c_f32_bf16_dpp v8, v28, v60 row_newbcast:12 row_mask:0xf bank_mask:0xf
  v_dot2c_f32_bf16_dpp v9, v29, v60 row_newbcast:12 row_mask:0xf bank_mask:0xf
  v_dot2c_f32_bf16_dpp v10, v28, v61 row_newbcast:12 row_mask:0xf bank_mask:0xf
  v_dot2c_f32_bf16_dpp v11, v29, v61 row_newbcast:12 row_mask:0xf bank_mask:0xf
  v_dot2c_f32_bf16_dpp v12, v28, v62 row_newbcast:12 row_mask:0xf bank_mask:0xf
  v_dot2c_f32_bf16_dpp v13, v29, v62 row_newbcast:12 row_mask:0xf bank_mask:0xf
  v_dot2c_f32_bf16_dpp v14, v28, v63 row_newbcast:12 row_mask:0xf bank_mask:0xf
  v_dot2c_f32_bf16_dpp v15, v29, v63 row_newbcast:12 row_mask:0xf bank_mask:0xf
  s_mov_b32 s87, s25
  s_branch L_loop3
L_tail0:
  buffer_load_dwordx4 v[96:99], v3, s[52:55], s90 offen offset:0 nt
  v_dot2c_f32_bf16_dpp v8, v28, v44 row_newbcast:12 row_mask:0xf bank_mask:0xf
  v_dot2c_f32_bf16_dpp v9, v29, v44 row_newbcast:12 row_mask:0xf bank_mask:0xf
  v_dot2c_f32_bf16_dpp v10, v28, v45 row_newbcast:12 row_mask:0xf bank_mask:0xf
  v_dot2c_f32_bf16_dpp v11, v29, v45 row_newbcast:12 row_mask:0xf bank_mask:0xf
  v_dot2c_f32_bf16_dpp v12, v28, v46 row_newbcast:12 row_mask:0xf bank_mask:0xf
  v_dot2c_f32_bf16_dpp v13, v29, v46 row_newbcast:12 row_mask:0xf bank_mask:0xf
  v_dot2c_f32_bf16_dpp v14, v28, v47 row_newbcast:12 row_mask:0xf bank_mask:0xf
  v_dot2c_f32_bf16_dpp v15, v29, v47 row_newbcast:12 row_mask:0xf bank_mask:0xf
  s_waitcnt vmcnt(4)
  s_add_u32 s93, s90, 8192
  buffer_load_dwordx4 v[100:103], v3, s[52:55], s93 offen offset:0 nt
  s_add_u32 s101, s90, 16384
  buffer_load_dwordx4 v[104:107], v3, s[52:55], s101 offen offset:0 nt
  v_dot2c_f32_bf16_dpp v8, v20, v48 row_newbcast:0 row_mask:0xf bank_mask:0xf
  v_dot2c_f32_bf16_dpp v9, v21, v48 row_newbcast:0 row_mask:0xf bank_mask:0xf
  v_dot2c_f32_bf16_dpp v10, v20, v49 row_newbcast:0 row_mask:0xf bank_mask:0xf
  v_dot2c_f32_bf16_dpp v11, v21, v49 row_newbcast:0 row_mask:0xf bank_mask:0xf
  v_dot2c_f32_bf16_dpp v12, v20, v50 row_newbcast:0 row_mask:0xf bank_mask:0xf
  v_dot2c_f32_bf16_dpp v13, v21, v50 row_newbcast:0 row_mask:0xf bank_mask:0xf
  v_dot2c_f32_bf16_dpp v14, v20, v51 row_newbcast:0 row_mask:0xf bank_mask:0xf
  v_dot2c_f32_bf16_dpp v15, v21, v51 row_newbcast:0 row_mask:0xf bank_mask:0xf
  s_waitcnt vmcnt(5)
  v_dot2c_f32_bf16_dpp v8, v20, v52 row_newbcast:8 row_mask:0xf bank_mask:0xf
  v_dot2c_f32_bf16_dpp v9, v21, v52 row_newbcast:8 row_mask:0xf bank_mask:0xf
  v_dot2c_f32_bf16_dpp v10, v20, v53 row_newbcast:8 row_mask:0xf bank_mask:0xf
  v_dot2c_f32_bf16_dpp v11, v21, v53 row_newbcast:8 row_mask:0xf bank_mask:0xf
  v_dot2c_f32_bf16_dpp v12, v20, v54 row_newbcast:8 row_mask:0xf bank_mask:0xf
  v_dot2c_f32_bf16_dpp v13, v21, v54 row_newbcast:8 row_mask:0xf bank_mask:0xf
  v_dot2c_f32_bf16_dpp v14, v20, v55 row_newbcast:8 row_mask:0xf bank_mask:0xf
  v_dot2c_f32_bf16_dpp v15, v21, v55 row_newbcast:8 row_mask:0xf bank_mask:0xf
  s_waitcnt vmcnt(4)
  s_add_u32 s93, s90, 24576
  buffer_load_dwordx4 v[108:111], v3, s[52:55], s93 offen offset:0 nt
  v_dot2c_f32_bf16_dpp v8, v20, v56 row_newbcast:4 row_mask:0xf bank_mask:0xf
  v_dot2c_f32_bf16_dpp v9, v21, v56 row_newbcast:4 row_mask:0xf bank_mask:0xf
  v_dot2c_f32_bf16_dpp v10, v20, v57 row_newbcast:4 row_mask:0xf bank_mask:0xf
  v_dot2c_f32_bf16_dpp v11, v21, v57 row_newbcast:4 row_mask:0xf bank_mask:0xf
  v_dot2c_f32_bf16_dpp v12, v20, v58 row_newbcast:4 row_mask:0xf bank_mask:0xf
  v_dot2c_f32_bf16_dpp v13, v21, v58 row_newbcast:4 row_mask:0xf bank_mask:0xf
  v_dot2c_f32_bf16_dpp v14, v20, v59 row_newbcast:4 row_mask:0xf bank_mask:0xf
  v_dot2c_f32_bf16_dpp v15, v21, v59 row_newbcast:4 row_mask:0xf bank_mask:0xf
  s_waitcnt vmcnt(4)
  s_add_u32 s93, s90, 32768
  buffer_load_dwordx4 v[112:115], v3, s[52:55], s93 offen offset:0 nt
  v_dot2c_f32_bf16_dpp v8, v20, v60 row_newbcast:12 row_mask:0xf bank_mask:0xf
  v_dot2c_f32_bf16_dpp v9, v21, v60 row_newbcast:12 row_mask:0xf bank_mask:0xf
  v_dot2c_f32_bf16_dpp v10, v20, v61 row_newbcast:12 row_mask:0xf bank_mask:0xf
  v_dot2c_f32_bf16_dpp v11, v21, v61 row_newbcast:12 row_mask:0xf bank_mask:0xf
  v_dot2c_f32_bf16_dpp v12, v20, v62 row_newbcast:12 row_mask:0xf bank_mask:0xf
  v_dot2c_f32_bf16_dpp v13, v21, v62 row_newbcast:12 row_mask:0xf bank_mask:0xf
  v_dot2c_f32_bf16_dpp v14, v20, v63 row_newbcast:12 row_mask:0xf bank_mask:0xf
  v_dot2c_f32_bf16_dpp v15, v21, v63 row_newbcast:12 row_mask:0xf bank_mask:0xf
  s_branch L_fin
L_drain:
  buffer_load_dwordx4 v[96:99], v3, s[52:55], s90 offen offset:0 nt
  v_dot2_f32_bf16 v21, v44, v4, 0
  v_dot2_f32_bf16 v21, v45, v5, v21
  v_dot2_f32_bf16 v21, v46, v6, v21
  v_dot2_f32_bf16 v21, v47, v7, v21
  v_add_f32_dpp v22, v18, v18 row_ror:8 row_mask:0xf bank_mask:0x3
  v_add_f32_dpp v23, v20, v20 row_ror:8 row_mask:0xf bank_mask:0x3
  s_nop 0
  v_add_f32_dpp v22, v19, v19 row_ror:8 row_mask:0xf bank_mask:0xc
  v_add_f32_dpp v23, v21, v21 row_ror:8 row_mask:0xf bank_mask:0xc
  s_nop 0
  v_add_f32_dpp v24, v22, v22 row_half_mirror row_mask:0xf bank_mask:0x5
  s_nop 1
  v_add_f32_dpp v24, v23, v23 row_half_mirror row_mask:0xf bank_mask:0xa
  s_nop 1
  v_add_f32_dpp v24, v24, v24 quad_perm:[1,0,3,2] row_mask:0xf bank_mask:0xf
  s_nop 1
  v_add_f32_dpp v24, v24, v24 quad_perm:[2,3,0,1] row_mask:0xf bank_mask:0xf
  s_nop 1
  v_max_f32_dpp v25, v24, v24 row_ror:4 row_mask:0xf bank_mask:0xf
  s_nop 1
  v_max_f32_dpp v25, v25, v25 row_ror:8 row_mask:0xf bank_mask:0xf
  v_mul_f32 v25, s92, v25
  v_max_f32 v30, v16, v25
  v_fma_f32 v24, v24, s92, -v30
  v_sub_f32 v26, v16, v30
  v_exp_f32 v24, v24
  v_exp_f32 v26, v26
  v_mov_b32 v16, v30
  v_cvt_pk_bf16_f32 v28, v24, 0
  v_fma_f32 v17, v17, v26, v24
  v_lshlrev_b32 v29, 16, v28
  v_pk_mul_f32 v[8:9], v[8:9], v[26:27] op_sel_hi:[1,0]
  v_pk_mul_f32 v[10:11], v[10:11], v[26:27] op_sel_hi:[1,0]
  v_pk_mul_f32 v[12:13], v[12:13], v[26:27] op_sel_hi:[1,0]
  v_pk_mul_f32 v[14:15], v[14:15], v[26:27] op_sel_hi:[1,0]
  s_waitcnt vmcnt(4)
  s_add_u32 s93, s90, 8192
  buffer_load_dwordx4 v[100:103], v3, s[52:55], s93 offen offset:0 nt
  s_add_u32 s101, s90, 16384
  buffer_load_dwordx4 v[104:107], v3, s[52:55], s101 offen offset:0 nt
  v_dot2c_f32_bf16_dpp v8, v28, v48 row_newbcast:0 row_mask:0xf bank_mask:0xf
  v_dot2c_f32_bf16_dpp v9, v29, v48 row_newbcast:0 row_mask:0xf bank_mask:0xf
  v_dot2c_f32_bf16_dpp v10, v28, v49 row_newbcast:0 row_mask:0xf bank_mask:0xf
  v_dot2c_f32_bf16_dpp v11, v29, v49 row_newbcast:0 row_mask:0xf bank_mask:0xf
  v_dot2c_f32_bf16_dpp v12, v28, v50 row_newbcast:0 row_mask:0xf bank_mask:0xf
  v_dot2c_f32_bf16_dpp v13, v29, v50 row_newbcast:0 row_mask:0xf bank_mask:0xf
  v_dot2c_f32_bf16_dpp v14, v28, v51 row_newbcast:0 row_mask:0xf bank_mask:0xf
  v_dot2c_f32_bf16_dpp v15, v29, v51 row_newbcast:0 row_mask:0xf bank_mask:0xf
  s_waitcnt vmcnt(5)
  v_dot2c_f32_bf16_dpp v8, v28, v52 row_newbcast:8 row_mask:0xf bank_mask:0xf
  v_dot2c_f32_bf16_dpp v9, v29, v52 row_newbcast:8 row_mask:0xf bank_mask:0xf
  v_dot2c_f32_bf16_dpp v10, v28, v53 row_newbcast:8 row_mask:0xf bank_mask:0xf
  v_dot2c_f32_bf16_dpp v11, v29, v53 row_newbcast:8 row_mask:0xf bank_mask:0xf
  v_dot2c_f32_bf16_dpp v12, v28, v54 row_newbcast:8 row_mask:0xf bank_mask:0xf
  v_dot2c_f32_bf16_dpp v13, v29, v54 row_newbcast:8 row_mask:0xf bank_mask:0xf
  v_dot2c_f32_bf16_dpp v14, v28, v55 row_newbcast:8 row_mask:0xf bank_mask:0xf
  v_dot2c_f32_bf16_dpp v15, v29, v55 row_newbcast:8 row_mask:0xf bank_mask:0xf
  s_waitcnt vmcnt(4)
  s_add_u32 s93, s90, 24576
  buffer_load_dwordx4 v[108:111], v3, s[52:55], s93 offen offset:0 nt
  v_dot2c_f32_bf16_dpp v8, v28, v56 row_newbcast:4 row_mask:0xf bank_mask:0xf
  v_dot2c_f32_bf16_dpp v9, v29, v56 row_newbcast:4 row_mask:0xf bank_mask:0xf
  v_dot2c_f32_bf16_dpp v10, v28, v57 row_newbcast:4 row_mask:0xf bank_mask:0xf
  v_dot2c_f32_bf16_dpp v11, v29, v57 row_newbcast:4 row_mask:0xf bank_mask:0xf
  v_dot2c_f32_bf16_dpp v12, v28, v58 row_newbcast:4 row_mask:0xf bank_mask:0xf
  v_dot2c_f32_bf16_dpp v13, v29, v58 row_newbcast:4 row_mask:0xf bank_mask:0xf
  v_dot2c_f32_bf16_dpp v14, v28, v59 row_newbcast:4 row_mask:0xf bank_mask:0xf
  v_dot2c_f32_bf16_dpp v15, v29, v59 row_newbcast:4 row_mask:0xf bank_mask:0xf
  s_waitcnt vmcnt(4)
  s_add_u32 s93, s90, 32768
  buffer_load_dwordx4 v[112:115], v3, s[52:55], s93 offen offset:0 nt
  v_dot2c_f32_bf16_dpp v8, v28, v60 row_newbcast:12 row_mask:0xf bank_mask:0xf
  v_dot2c_f32_bf16_dpp v9, v29, v60 row_newbcast:12 row_mask:0xf bank_mask:0xf
  v_dot2c_f32_bf16_dpp v10, v28, v61 row_newbcast:12 row_mask:0xf bank_mask:0xf
  v_dot2c_f32_bf16_dpp v11, v29, v61 row_newbcast:12 row_mask:0xf bank_mask:0xf
  v_dot2c_f32_bf16_dpp v12, v28, v62 row_newbcast:12 row_mask:0xf bank_mask:0xf
  v_dot2c_f32_bf16_dpp v13, v29, v62 row_newbcast:12 row_mask:0xf bank_mask:0xf
  v_dot2c_f32_bf16_dpp v14, v28, v63 row_newbcast:12 row_mask:0xf bank_mask:0xf
  v_dot2c_f32_bf16_dpp v15, v29, v63 row_newbcast:12 row_mask:0xf bank_mask:0xf
  s_branch L_fin
L_tail0_f:
  buffer_load_dwordx4 v[128:131], v253, s[32:35], s25 offen offset:0 nt
  s_xor_b32 s93, s25, 0x300
  buffer_load_dwordx4 v[132:135], v253, s[32:35], s93 offen offset:0 nt
  s_xor_b32 s93, s25, 0x40000
  buffer_load_dwordx4 v[136:139], v253, s[32:35], s93 offen offset:0 nt
  s_xor_b32 s93, s25, 0x40300
  buffer_load_dwordx4 v[140:143], v253, s[32:35], s93 offen offset:0 nt
  buffer_load_dwordx4 v[144:147], v253, s[36:39], s25 offen offset:0 nt
  s_xor_b32 s93, s25, 0x300
  buffer_load_dwordx4 v[148:151], v253, s[36:39], s93 offen offset:0 nt
  s_xor_b32 s93, s25, 0x40000
  buffer_load_dwordx4 v[152:155], v253, s[36:39], s93 offen offset:0 nt
  s_xor_b32 s93, s25, 0x40300
  buffer_load_dwordx4 v[156:159], v253, s[36:39], s93 offen offset:0 nt
  v_dot2c_f32_bf16_dpp v8, v28, v44 row_newbcast:12 row_mask:0xf bank_mask:0xf
  v_dot2c_f32_bf16_dpp v9, v29, v44 row_newbcast:12 row_mask:0xf bank_mask:0xf
  v_dot2c_f32_bf16_dpp v10, v28, v45 row_newbcast:12 row_mask:0xf bank_mask:0xf
  v_dot2c_f32_bf16_dpp v11, v29, v45 row_newbcast:12 row_mask:0xf bank_mask:0xf
  v_dot2c_f32_bf16_dpp v12, v28, v46 row_newbcast:12 row_mask:0xf bank_mask:0xf
  v_dot2c_f32_bf16_dpp v13, v29, v46 row_newbcast:12 row_mask:0xf bank_mask:0xf
  v_dot2c_f32_bf16_dpp v14, v28, v47 row_newbcast:12 row_mask:0xf bank_mask:0xf
  v_dot2c_f32_bf16_dpp v15, v29, v47 row_newbcast:12 row_mask:0xf bank_mask:0xf
  s_waitcnt vmcnt(11)
  v_dot2c_f32_bf16_dpp v8, v20, v48 row_newbcast:0 row_mask:0xf bank_mask:0xf
  v_dot2c_f32_bf16_dpp v9, v21, v48 row_newbcast:0 row_mask:0xf bank_mask:0xf
  v_dot2c_f32_bf16_dpp v10, v20, v49 row_newbcast:0 row_mask:0xf bank_mask:0xf
  v_dot2c_f32_bf16_dpp v11, v21, v49 row_newbcast:0 row_mask:0xf bank_mask:0xf
  v_dot2c_f32_bf16_dpp v12, v20, v50 row_newbcast:0 row_mask:0xf bank_mask:0xf
  v_dot2c_f32_bf16_dpp v13, v21, v50 row_newbcast:0 row_mask:0xf bank_mask:0xf
  v_dot2c_f32_bf16_dpp v14, v20, v51 row_newbcast:0 row_mask:0xf bank_mask:0xf
  v_dot2c_f32_bf16_dpp v15, v21, v51 row_newbcast:0 row_mask:0xf bank_mask:0xf
  s_waitcnt vmcnt(10)
  v_dot2c_f32_bf16_dpp v8, v20, v52 row_newbcast:8 row_mask:0xf bank_mask:0xf
  v_dot2c_f32_bf16_dpp v9, v21, v52 row_newbcast:8 row_mask:0xf bank_mask:0xf
  v_dot2c_f32_bf16_dpp v10, v20, v53 row_newbcast:8 row_mask:0xf bank_mask:0xf
  v_dot2c_f32_bf16_dpp v11, v21, v53 row_newbcast:8 row_mask:0xf bank_mask:0xf
  v_dot2c_f32_bf16_dpp v12, v20, v54 row_newbcast:8 row_mask:0xf bank_mask:0xf
  v_dot2c_f32_bf16_dpp v13, v21, v54 row_newbcast:8 row_mask:0xf bank_mask:0xf
  v_dot2c_f32_bf16_dpp v14, v20, v55 row_newbcast:8 row_mask:0xf bank_mask:0xf
  v_dot2c_f32_bf16_dpp v15, v21, v55 row_newbcast:8 row_mask:0xf bank_mask:0xf
  s_waitcnt vmcnt(9)
  v_dot2c_f32_bf16_dpp v8, v20, v56 row_newbcast:4 row_mask:0xf bank_mask:0xf
  v_dot2c_f32_bf16_dpp v9, v21, v56 row_newbcast:4 row_mask:0xf bank_mask:0xf
  v_dot2c_f32_bf16_dpp v10, v20, v57 row_newbcast:4 row_mask:0xf bank_mask:0xf
  v_dot2c_f32_bf16_dpp v11, v21, v57 row_newbcast:4 row_mask:0xf bank_mask:0xf
  v_dot2c_f32_bf16_dpp v12, v20, v58 row_newbcast:4 row_mask:0xf bank_mask:0xf
  v_dot2c_f32_bf16_dpp v13, v21, v58 row_newbcast:4 row_mask:0xf bank_mask:0xf
  v_dot2c_f32_bf16_dpp v14, v20, v59 row_newbcast:4 row_mask:0xf bank_mask:0xf
  v_dot2c_f32_bf16_dpp v15, v21, v59 row_newbcast:4 row_mask:0xf bank_mask:0xf
  s_waitcnt vmcnt(8)
  v_dot2c_f32_bf16_dpp v8, v20, v60 row_newbcast:12 row_mask:0xf bank_mask:0xf
  v_dot2c_f32_bf16_dpp v9, v21, v60 row_newbcast:12 row_mask:0xf bank_mask:0xf
  v_dot2c_f32_bf16_dpp v10, v20, v61 row_newbcast:12 row_mask:0xf bank_mask:0xf
  v_dot2c_f32_bf16_dpp v11, v21, v61 row_newbcast:12 row_mask:0xf bank_mask:0xf
  v_dot2c_f32_bf16_dpp v12, v20, v62 row_newbcast:12 row_mask:0xf bank_mask:0xf
  v_dot2c_f32_bf16_dpp v13, v21, v62 row_newbcast:12 row_mask:0xf bank_mask:0xf
  v_dot2c_f32_bf16_dpp v14, v20, v63 row_newbcast:12 row_mask:0xf bank_mask:0xf
  v_dot2c_f32_bf16_dpp v15, v21, v63 row_newbcast:12 row_mask:0xf bank_mask:0xf
  s_branch L_final
L_drain_f:
  buffer_load_dwordx4 v[128:131], v253, s[32:35], s25 offen offset:0 nt
  s_xor_b32 s93, s25, 0x300
  buffer_load_dwordx4 v[132:135], v253, s[32:35], s93 offen offset:0 nt
  s_xor_b32 s93, s25, 0x40000
  buffer_load_dwordx4 v[136:139], v253, s[32:35], s93 offen offset:0 nt
  s_xor_b32 s93, s25, 0x40300
  buffer_load_dwordx4 v[140:143], v253, s[32:35], s93 offen offset:0 nt
  buffer_load_dwordx4 v[144:147], v253, s[36:39], s25 offen offset:0 nt
  s_xor_b32 s93, s25, 0x300
  buffer_load_dwordx4 v[148:151], v253, s[36:39], s93 offen offset:0 nt
  s_xor_b32 s93, s25, 0x40000
  buffer_load_dwordx4 v[152:155], v253, s[36:39], s93 offen offset:0 nt
  s_xor_b32 s93, s25, 0x40300
  buffer_load_dwordx4 v[156:159], v253, s[36:39], s93 offen offset:0 nt
  v_dot2_f32_bf16 v21, v44, v4, 0
  v_dot2_f32_bf16 v21, v45, v5, v21
  v_dot2_f32_bf16 v21, v46, v6, v21
  v_dot2_f32_bf16 v21, v47, v7, v21
  v_add_f32_dpp v22, v18, v18 row_ror:8 row_mask:0xf bank_mask:0x3
  v_add_f32_dpp v23, v20, v20 row_ror:8 row_mask:0xf bank_mask:0x3
  s_nop 0
  v_add_f32_dpp v22, v19, v19 row_ror:8 row_mask:0xf bank_mask:0xc
  v_add_f32_dpp v23, v21, v21 row_ror:8 row_mask:0xf bank_mask:0xc
  s_nop 0
  v_add_f32_dpp v24, v22, v22 row_half_mirror row_mask:0xf bank_mask:0x5
  s_nop 1
  v_add_f32_dpp v24, v23, v23 row_half_mirror row_mask:0xf bank_mask:0xa
  s_nop 1
  v_add_f32_dpp v24, v24, v24 quad_perm:[1,0,3,2] row_mask:0xf bank_mask:0xf
  s_nop 1
  v_add_f32_dpp v24, v24, v24 quad_perm:[2,3,0,1] row_mask:0xf bank_mask:0xf
  s_nop 1
  v_max_f32_dpp v25, v24, v24 row_ror:4 row_mask:0xf bank_mask:0xf
  s_nop 1
  v_max_f32_dpp v25, v25, v25 row_ror:8 row_mask:0xf bank_mask:0xf
  v_mul_f32 v25, s92, v25
  v_max_f32 v30, v16, v25
  v_fma_f32 v24, v24, s92, -v30
  v_sub_f32 v26, v16, v30
  v_exp_f32 v24, v24
  v_exp_f32 v26, v26
  v_mov_b32 v16, v30
  v_cvt_pk_bf16_f32 v28, v24, 0
  v_fma_f32 v17, v17, v26, v24
  v_lshlrev_b32 v29, 16, v28
  v_pk_mul_f32 v[8:9], v[8:9], v[26:27] op_sel_hi:[1,0]
  v_pk_mul_f32 v[10:11], v[10:11], v[26:27] op_sel_hi:[1,0]
  v_pk_mul_f32 v[12:13], v[12:13], v[26:27] op_sel_hi:[1,0]
  v_pk_mul_f32 v[14:15], v[14:15], v[26:27] op_sel_hi:[1,0]
  s_waitcnt vmcnt(11)
  v_dot2c_f32_bf16_dpp v8, v28, v48 row_newbcast:0 row_mask:0xf bank_mask:0xf
  v_dot2c_f32_bf16_dpp v9, v29, v48 row_newbcast:0 row_mask:0xf bank_mask:0xf
  v_dot2c_f32_bf16_dpp v10, v28, v49 row_newbcast:0 row_mask:0xf bank_mask:0xf
  v_dot2c_f32_bf16_dpp v11, v29, v49 row_newbcast:0 row_mask:0xf bank_mask:0xf
  v_dot2c_f32_bf16_dpp v12, v28, v50 row_newbcast:0 row_mask:0xf bank_mask:0xf
  v_dot2c_f32_bf16_dpp v13, v29, v50 row_newbcast:0 row_mask:0xf bank_mask:0xf
  v_dot2c_f32_bf16_dpp v14, v28, v51 row_newbcast:0 row_mask:0xf bank_mask:0xf
  v_dot2c_f32_bf16_dpp v15, v29, v51 row_newbcast:0 row_mask:0xf bank_mask:0xf
  s_waitcnt vmcnt(10)
  v_dot2c_f32_bf16_dpp v8, v28, v52 row_newbcast:8 row_mask:0xf bank_mask:0xf
  v_dot2c_f32_bf16_dpp v9, v29, v52 row_newbcast:8 row_mask:0xf bank_mask:0xf
  v_dot2c_f32_bf16_dpp v10, v28, v53 row_newbcast:8 row_mask:0xf bank_mask:0xf
  v_dot2c_f32_bf16_dpp v11, v29, v53 row_newbcast:8 row_mask:0xf bank_mask:0xf
  v_dot2c_f32_bf16_dpp v12, v28, v54 row_newbcast:8 row_mask:0xf bank_mask:0xf
  v_dot2c_f32_bf16_dpp v13, v29, v54 row_newbcast:8 row_mask:0xf bank_mask:0xf
  v_dot2c_f32_bf16_dpp v14, v28, v55 row_newbcast:8 row_mask:0xf bank_mask:0xf
  v_dot2c_f32_bf16_dpp v15, v29, v55 row_newbcast:8 row_mask:0xf bank_mask:0xf
  s_waitcnt vmcnt(9)
  v_dot2c_f32_bf16_dpp v8, v28, v56 row_newbcast:4 row_mask:0xf bank_mask:0xf
  v_dot2c_f32_bf16_dpp v9, v29, v56 row_newbcast:4 row_mask:0xf bank_mask:0xf
  v_dot2c_f32_bf16_dpp v10, v28, v57 row_newbcast:4 row_mask:0xf bank_mask:0xf
  v_dot2c_f32_bf16_dpp v11, v29, v57 row_newbcast:4 row_mask:0xf bank_mask:0xf
  v_dot2c_f32_bf16_dpp v12, v28, v58 row_newbcast:4 row_mask:0xf bank_mask:0xf
  v_dot2c_f32_bf16_dpp v13, v29, v58 row_newbcast:4 row_mask:0xf bank_mask:0xf
  v_dot2c_f32_bf16_dpp v14, v28, v59 row_newbcast:4 row_mask:0xf bank_mask:0xf
  v_dot2c_f32_bf16_dpp v15, v29, v59 row_newbcast:4 row_mask:0xf bank_mask:0xf
  s_waitcnt vmcnt(8)
  v_dot2c_f32_bf16_dpp v8, v28, v60 row_newbcast:12 row_mask:0xf bank_mask:0xf
  v_dot2c_f32_bf16_dpp v9, v29, v60 row_newbcast:12 row_mask:0xf bank_mask:0xf
  v_dot2c_f32_bf16_dpp v10, v28, v61 row_newbcast:12 row_mask:0xf bank_mask:0xf
  v_dot2c_f32_bf16_dpp v11, v29, v61 row_newbcast:12 row_mask:0xf bank_mask:0xf
  v_dot2c_f32_bf16_dpp v12, v28, v62 row_newbcast:12 row_mask:0xf bank_mask:0xf
  v_dot2c_f32_bf16_dpp v13, v29, v62 row_newbcast:12 row_mask:0xf bank_mask:0xf
  v_dot2c_f32_bf16_dpp v14, v28, v63 row_newbcast:12 row_mask:0xf bank_mask:0xf
  v_dot2c_f32_bf16_dpp v15, v29, v63 row_newbcast:12 row_mask:0xf bank_mask:0xf
L_final:
  s_waitcnt vmcnt(7)
  v_dot2_f32_bf16 v18, v128, v4, 0
  v_dot2_f32_bf16 v18, v129, v5, v18
  v_dot2_f32_bf16 v18, v130, v6, v18
  v_dot2_f32_bf16 v18, v131, v7, v18
  s_waitcnt vmcnt(6)
  v_dot2_f32_bf16 v19, v132, v4, 0
  v_dot2_f32_bf16 v19, v133, v5, v19
  v_dot2_f32_bf16 v19, v134, v6, v19
  v_dot2_f32_bf16 v19, v135, v7, v19
  s_waitcnt vmcnt(5)
  v_dot2_f32_bf16 v20, v136, v4, 0
  v_dot2_f32_bf16 v20, v137, v5, v20
  v_dot2_f32_bf16 v20, v138, v6, v20
  v_dot2_f32_bf16 v20, v139, v7, v20
  s_waitcnt vmcnt(4)
  buffer_load_dwordx4 v[96:99], v3, s[52:55], s90 offen offset:0 nt
  v_dot2_f32_bf16 v21, v140, v4, 0
  v_dot2_f32_bf16 v21, v141, v5, v21
  v_dot2_f32_bf16 v21, v142, v6, v21
  v_dot2_f32_bf16 v21, v143, v7, v21
  v_add_f32_dpp v22, v18, v18 row_ror:8 row_mask:0xf bank_mask:0x3
  v_add_f32_dpp v23, v20, v20 row_ror:8 row_mask:0xf bank_mask:0x3
  s_nop 0
  v_add_f32_dpp v22, v19, v19 row_ror:8 row_mask:0xf bank_mask:0xc
  v_add_f32_dpp v23, v21, v21 row_ror:8 row_mask:0xf bank_mask:0xc
  s_nop 0
  v_add_f32_dpp v24, v22, v22 row_half_mirror row_mask:0xf bank_mask:0x5
  s_nop 1
  v_add_f32_dpp v24, v23, v23 row_half_mirror row_mask:0xf bank_mask:0xa
  s_nop 1
  v_add_f32_dpp v24, v24, v24 quad_perm:[1,0,3,2] row_mask:0xf bank_mask:0xf
  s_nop 1
  v_add_f32_dpp v24, v24, v24 quad_perm:[2,3,0,1] row_mask:0xf bank_mask:0xf
  s_nop 1
  v_max_f32_dpp v25, v24, v24 row_ror:4 row_mask:0xf bank_mask:0xf
  s_nop 1
  v_max_f32_dpp v25, v25, v25 row_ror:8 row_mask:0xf bank_mask:0xf
  v_mul_f32 v25, s92, v25
  v_max_f32 v30, v16, v25
  v_fma_f32 v24, v24, s92, -v30
  v_sub_f32 v26, v16, v30
  v_exp_f32 v24, v24
  v_exp_f32 v26, v26
  v_mov_b32 v16, v30
  v_cvt_pk_bf16_f32 v28, v24, 0
  v_fma_f32 v17, v17, v26, v24
  v_lshlrev_b32 v29, 16, v28
  v_pk_mul_f32 v[8:9], v[8:9], v[26:27] op_sel_hi:[1,0]
  v_pk_mul_f32 v[10:11], v[10:11], v[26:27] op_sel_hi:[1,0]
  v_pk_mul_f32 v[12:13], v[12:13], v[26:27] op_sel_hi:[1,0]
  v_pk_mul_f32 v[14:15], v[14:15], v[26:27] op_sel_hi:[1,0]
  s_waitcnt vmcnt(4)
  s_add_u32 s93, s90, 8192
  buffer_load_dwordx4 v[100:103], v3, s[52:55], s93 offen offset:0 nt
  v_dot2c_f32_bf16_dpp v8, v28, v144 row_newbcast:0 row_mask:0xf bank_mask:0xf
  v_dot2c_f32_bf16_dpp v9, v29, v144 row_newbcast:0 row_mask:0xf bank_mask:0xf
  v_dot2c_f32_bf16_dpp v10, v28, v145 row_newbcast:0 row_mask:0xf bank_mask:0xf
  v_dot2c_f32_bf16_dpp v11, v29, v145 row_newbcast:0 row_mask:0xf bank_mask:0xf
  v_dot2c_f32_bf16_dpp v12, v28, v146 row_newbcast:0 row_mask:0xf bank_mask:0xf
  v_dot2c_f32_bf16_dpp v13, v29, v146 row_newbcast:0 row_mask:0xf bank_mask:0xf
  v_dot2c_f32_bf16_dpp v14, v28, v147 row_newbcast:0 row_mask:0xf bank_mask:0xf
  v_dot2c_f32_bf16_dpp v15, v29, v147 row_newbcast:0 row_mask:0xf bank_mask:0xf
  s_waitcnt vmcnt(4)
  s_add_u32 s93, s90, 16384
  buffer_load_dwordx4 v[104:107], v3, s[52:55], s93 offen offset:0 nt
  v_dot2c_f32_bf16_dpp v8, v28, v148 row_newbcast:8 row_mask:0xf bank_mask:0xf
  v_dot2c_f32_bf16_dpp v9, v29, v148 row_newbcast:8 row_mask:0xf bank_mask:0xf
  v_dot2c_f32_bf16_dpp v10, v28, v149 row_newbcast:8 row_mask:0xf bank_mask:0xf
  v_dot2c_f32_bf16_dpp v11, v29, v149 row_newbcast:8 row_mask:0xf bank_mask:0xf
  v_dot2c_f32_bf16_dpp v12, v28, v150 row_newbcast:8 row_mask:0xf bank_mask:0xf
  v_dot2c_f32_bf16_dpp v13, v29, v150 row_newbcast:8 row_mask:0xf bank_mask:0xf
  v_dot2c_f32_bf16_dpp v14, v28, v151 row_newbcast:8 row_mask:0xf bank_mask:0xf
  v_dot2c_f32_bf16_dpp v15, v29, v151 row_newbcast:8 row_mask:0xf bank_mask:0xf
  s_waitcnt vmcnt(4)
  s_add_u32 s93, s90, 24576
  buffer_load_dwordx4 v[108:111], v3, s[52:55], s93 offen offset:0 nt
  v_dot2c_f32_bf16_dpp v8, v28, v152 row_newbcast:4 row_mask:0xf bank_mask:0xf
  v_dot2c_f32_bf16_dpp v9, v29, v152 row_newbcast:4 row_mask:0xf bank_mask:0xf
  v_dot2c_f32_bf16_dpp v10, v28, v153 row_newbcast:4 row_mask:0xf bank_mask:0xf
  v_dot2c_f32_bf16_dpp v11, v29, v153 row_newbcast:4 row_mask:0xf bank_mask:0xf
  v_dot2c_f32_bf16_dpp v12, v28, v154 row_newbcast:4 row_mask:0xf bank_mask:0xf
  v_dot2c_f32_bf16_dpp v13, v29, v154 row_newbcast:4 row_mask:0xf bank_mask:0xf
  v_dot2c_f32_bf16_dpp v14, v28, v155 row_newbcast:4 row_mask:0xf bank_mask:0xf
  v_dot2c_f32_bf16_dpp v15, v29, v155 row_newbcast:4 row_mask:0xf bank_mask:0xf
  s_waitcnt vmcnt(4)
  s_add_u32 s93, s90, 32768
  buffer_load_dwordx4 v[112:115], v3, s[52:55], s93 offen offset:0 nt
  v_dot2c_f32_bf16_dpp v8, v28, v156 row_newbcast:12 row_mask:0xf bank_mask:0xf
  v_dot2c_f32_bf16_dpp v9, v29, v156 row_newbcast:12 row_mask:0xf bank_mask:0xf
  v_dot2c_f32_bf16_dpp v10, v28, v157 row_newbcast:12 row_mask:0xf bank_mask:0xf
  v_dot2c_f32_bf16_dpp v11, v29, v157 row_newbcast:12 row_mask:0xf bank_mask:0xf
  v_dot2c_f32_bf16_dpp v12, v28, v158 row_newbcast:12 row_mask:0xf bank_mask:0xf
  v_dot2c_f32_bf16_dpp v13, v29, v158 row_newbcast:12 row_mask:0xf bank_mask:0xf
  v_dot2c_f32_bf16_dpp v14, v28, v159 row_newbcast:12 row_mask:0xf bank_mask:0xf
  v_dot2c_f32_bf16_dpp v15, v29, v159 row_newbcast:12 row_mask:0xf bank_mask:0xf
L_fin:
  s_add_u32 s93, s90, 40960
  buffer_load_dwordx4 v[116:119], v3, s[52:55], s93 offen offset:0 nt
  s_add_u32 s93, s90, 49152
  buffer_load_dwordx4 v[120:123], v3, s[52:55], s93 offen offset:0 nt
  s_add_u32 s93, s90, 57344
  buffer_load_dwordx4 v[124:127], v3, s[52:55], s93 offen offset:0 nt
  v_mov_b32 v246, v16
  v_mov_b32 v247, v16
  s_nop 1
  v_permlane32_swap_b32 v246, v247
  v_max_f32 v246, v246, v247
  v_mov_b32 v247, v246
  s_nop 1
  v_permlane16_swap_b32 v246, v247
  v_max_f32 v244, v246, v247
  v_sub_f32 v26, v16, v244
  v_exp_f32 v26, v26
  v_add_f32_dpp v22, v17, v17 row_ror:4 row_mask:0xf bank_mask:0xf
  v_pk_mul_f32 v[8:9], v[8:9], v[26:27] op_sel_hi:[1,0]
  v_pk_mul_f32 v[10:11], v[10:11], v[26:27] op_sel_hi:[1,0]
  v_pk_mul_f32 v[12:13], v[12:13], v[26:27] op_sel_hi:[1,0]
  v_pk_mul_f32 v[14:15], v[14:15], v[26:27] op_sel_hi:[1,0]
  v_add_f32_dpp v22, v22, v22 row_ror:8 row_mask:0xf bank_mask:0xf
  v_mul_f32 v22, v22, v26
  v_mov_b32 v246, v22
  v_mov_b32 v247, v22
  s_nop 1
  v_permlane32_swap_b32 v246, v247
  v_add_f32 v246, v246, v247
  v_mov_b32 v247, v246
  s_nop 1
  v_permlane16_swap_b32 v246, v247
  v_add_f32 v245, v246, v247
  ds_write_b64 v241, v[244:245] offset:4352
  v_permlane32_swap_b32 v8, v12
  v_permlane32_swap_b32 v10, v14
  v_permlane32_swap_b32 v9, v13
  v_permlane32_swap_b32 v11, v15
  v_add_f32 v8, v8, v12
  v_add_f32 v10, v10, v14
  v_add_f32 v9, v9, v13
  v_add_f32 v11, v11, v15
  v_permlane16_swap_b32 v8, v10
  s_nop 0
  v_permlane16_swap_b32 v9, v11
  v_add_f32 v8, v8, v10
  v_add_f32 v9, v9, v11
  ds_write_b64 v240, v[8:9] offset:4352
  s_waitcnt lgkmcnt(0)
  s_barrier
  ds_read_u16 v28, v242 offset:28544
  s_mov_b32 s64, s28
  s_mov_b32 s65, s29
  s_mov_b32 s66, 1310720
  s_mov_b32 s67, 0x20000
  v_and_b32 v4, 0xfc, v242
  v_lshlrev_b32 v4, 2, v4
  v_bfe_u32 v5, v0, 3, 1
  v_lshl_add_u32 v4, v5, 14, v4
  v_and_b32 v5, 16, v0
  v_cmp_ne_u32 s[76:77], 0, v5
  s_lshl_b32 s31, s84, 15
  s_add_u32 s31, s31, 1024
  s_mov_b32 s94, 2097152
  s_barrier
  buffer_load_dwordx4 v[64:67], v3, s[48:51], s90 offen offset:0 nt
  s_add_u32 s93, s90, 8192
  buffer_load_dwordx4 v[68:71], v3, s[48:51], s93 offen offset:0 nt
  s_add_u32 s93, s90, 16384
  buffer_load_dwordx4 v[72:75], v3, s[48:51], s93 offen offset:0 nt
  s_add_u32 s93, s90, 24576
  buffer_load_dwordx4 v[76:79], v3, s[48:51], s93 offen offset:0 nt
  s_add_u32 s93, s90, 32768
  buffer_load_dwordx4 v[80:83], v3, s[48:51], s93 offen offset:0 nt
  s_add_u32 s93, s90, 40960
  buffer_load_dwordx4 v[84:87], v3, s[48:51], s93 offen offset:0 nt
  s_add_u32 s93, s90, 49152
  buffer_load_dwordx4 v[88:91], v3, s[48:51], s93 offen offset:0 nt
  s_add_u32 s93, s90, 57344
  buffer_load_dwordx4 v[92:95], v3, s[48:51], s93 offen offset:0 nt
  buffer_load_dwordx4 v[32:35], v4, s[64:67], s31 offen sc1
  s_add_u32 s93, s31, 4096
  buffer_load_dwordx4 v[36:39], v4, s[64:67], s93 offen sc1
  s_add_u32 s93, s31, 8192
  buffer_load_dwordx4 v[40:43], v4, s[64:67], s93 offen sc1
  s_add_u32 s93, s31, 12288
  buffer_load_dwordx4 v[44:47], v4, s[64:67], s93 offen sc1
  v_mov_b32 v8, 0
  v_mov_b32 v9, 0
  v_mov_b32 v10, 0
  v_mov_b32 v11, 0
  v_mov_b32 v12, 0
  v_mov_b32 v13, 0
  v_mov_b32 v14, 0
  v_mov_b32 v15, 0
  s_waitcnt vmcnt(12) lgkmcnt(0)
  v_lshlrev_b32 v29, 16, v28
  v_dot2c_f32_bf16_dpp v8, v28, v96 row_newbcast:0 row_mask:0xf bank_mask:0xf
  s_nop 0
  v_dot2c_f32_bf16_dpp v9, v29, v96 row_newbcast:0 row_mask:0xf bank_mask:0xf
  v_dot2c_f32_bf16_dpp v10, v28, v97 row_newbcast:0 row_mask:0xf bank_mask:0xf
  v_dot2c_f32_bf16_dpp v11, v29, v97 row_newbcast:0 row_mask:0xf bank_mask:0xf
  v_dot2c_f32_bf16_dpp v12, v28, v98 row_newbcast:0 row_mask:0xf bank_mask:0xf
  v_dot2c_f32_bf16_dpp v13, v29, v98 row_newbcast:0 row_mask:0xf bank_mask:0xf
  v_dot2c_f32_bf16_dpp v14, v28, v99 row_newbcast:0 row_mask:0xf bank_mask:0xf
  v_dot2c_f32_bf16_dpp v15, v29, v99 row_newbcast:0 row_mask:0xf bank_mask:0xf
  v_dot2c_f32_bf16_dpp v8, v28, v100 row_newbcast:1 row_mask:0xf bank_mask:0xf
  v_dot2c_f32_bf16_dpp v9, v29, v100 row_newbcast:1 row_mask:0xf bank_mask:0xf
  v_dot2c_f32_bf16_dpp v10, v28, v101 row_newbcast:1 row_mask:0xf bank_mask:0xf
  v_dot2c_f32_bf16_dpp v11, v29, v101 row_newbcast:1 row_mask:0xf bank_mask:0xf
  v_dot2c_f32_bf16_dpp v12, v28, v102 row_newbcast:1 row_mask:0xf bank_mask:0xf
  v_dot2c_f32_bf16_dpp v13, v29, v102 row_newbcast:1 row_mask:0xf bank_mask:0xf
  v_dot2c_f32_bf16_dpp v14, v28, v103 row_newbcast:1 row_mask:0xf bank_mask:0xf
  v_dot2c_f32_bf16_dpp v15, v29, v103 row_newbcast:1 row_mask:0xf bank_mask:0xf
  v_dot2c_f32_bf16_dpp v8, v28, v104 row_newbcast:2 row_mask:0xf bank_mask:0xf
  v_dot2c_f32_bf16_dpp v9, v29, v104 row_newbcast:2 row_mask:0xf bank_mask:0xf
  v_dot2c_f32_bf16_dpp v10, v28, v105 row_newbcast:2 row_mask:0xf bank_mask:0xf
  v_dot2c_f32_bf16_dpp v11, v29, v105 row_newbcast:2 row_mask:0xf bank_mask:0xf
  v_dot2c_f32_bf16_dpp v12, v28, v106 row_newbcast:2 row_mask:0xf bank_mask:0xf
  v_dot2c_f32_bf16_dpp v13, v29, v106 row_newbcast:2 row_mask:0xf bank_mask:0xf
  v_dot2c_f32_bf16_dpp v14, v28, v107 row_newbcast:2 row_mask:0xf bank_mask:0xf
  v_dot2c_f32_bf16_dpp v15, v29, v107 row_newbcast:2 row_mask:0xf bank_mask:0xf
  v_dot2c_f32_bf16_dpp v8, v28, v108 row_newbcast:3 row_mask:0xf bank_mask:0xf
  v_dot2c_f32_bf16_dpp v9, v29, v108 row_newbcast:3 row_mask:0xf bank_mask:0xf
  v_dot2c_f32_bf16_dpp v10, v28, v109 row_newbcast:3 row_mask:0xf bank_mask:0xf
  v_dot2c_f32_bf16_dpp v11, v29, v109 row_newbcast:3 row_mask:0xf bank_mask:0xf
  v_dot2c_f32_bf16_dpp v12, v28, v110 row_newbcast:3 row_mask:0xf bank_mask:0xf
  v_dot2c_f32_bf16_dpp v13, v29, v110 row_newbcast:3 row_mask:0xf bank_mask:0xf
  v_dot2c_f32_bf16_dpp v14, v28, v111 row_newbcast:3 row_mask:0xf bank_mask:0xf
  v_dot2c_f32_bf16_dpp v15, v29, v111 row_newbcast:3 row_mask:0xf bank_mask:0xf
  v_dot2c_f32_bf16_dpp v8, v28, v112 row_newbcast:4 row_mask:0xf bank_mask:0xf
  v_dot2c_f32_bf16_dpp v9, v29, v112 row_newbcast:4 row_mask:0xf bank_mask:0xf
  v_dot2c_f32_bf16_dpp v10, v28, v113 row_newbcast:4 row_mask:0xf bank_mask:0xf
  v_dot2c_f32_bf16_dpp v11, v29, v113 row_newbcast:4 row_mask:0xf bank_mask:0xf
  v_dot2c_f32_bf16_dpp v12, v28, v114 row_newbcast:4 row_mask:0xf bank_mask:0xf
  v_dot2c_f32_bf16_dpp v13, v29, v114 row_newbcast:4 row_mask:0xf bank_mask:0xf
  v_dot2c_f32_bf16_dpp v14, v28, v115 row_newbcast:4 row_mask:0xf bank_mask:0xf
  v_dot2c_f32_bf16_dpp v15, v29, v115 row_newbcast:4 row_mask:0xf bank_mask:0xf
  v_dot2c_f32_bf16_dpp v8, v28, v116 row_newbcast:5 row_mask:0xf bank_mask:0xf
  v_dot2c_f32_bf16_dpp v9, v29, v116 row_newbcast:5 row_mask:0xf bank_mask:0xf
  v_dot2c_f32_bf16_dpp v10, v28, v117 row_newbcast:5 row_mask:0xf bank_mask:0xf
  v_dot2c_f32_bf16_dpp v11, v29, v117 row_newbcast:5 row_mask:0xf bank_mask:0xf
  v_dot2c_f32_bf16_dpp v12, v28, v118 row_newbcast:5 row_mask:0xf bank_mask:0xf
  v_dot2c_f32_bf16_dpp v13, v29, v118 row_newbcast:5 row_mask:0xf bank_mask:0xf
  v_dot2c_f32_bf16_dpp v14, v28, v119 row_newbcast:5 row_mask:0xf bank_mask:0xf
  v_dot2c_f32_bf16_dpp v15, v29, v119 row_newbcast:5 row_mask:0xf bank_mask:0xf
  v_dot2c_f32_bf16_dpp v8, v28, v120 row_newbcast:6 row_mask:0xf bank_mask:0xf
  v_dot2c_f32_bf16_dpp v9, v29, v120 row_newbcast:6 row_mask:0xf bank_mask:0xf
  v_dot2c_f32_bf16_dpp v10, v28, v121 row_newbcast:6 row_mask:0xf bank_mask:0xf
  v_dot2c_f32_bf16_dpp v11, v29, v121 row_newbcast:6 row_mask:0xf bank_mask:0xf
  v_dot2c_f32_bf16_dpp v12, v28, v122 row_newbcast:6 row_mask:0xf bank_mask:0xf
  v_dot2c_f32_bf16_dpp v13, v29, v122 row_newbcast:6 row_mask:0xf bank_mask:0xf
  v_dot2c_f32_bf16_dpp v14, v28, v123 row_newbcast:6 row_mask:0xf bank_mask:0xf
  v_dot2c_f32_bf16_dpp v15, v29, v123 row_newbcast:6 row_mask:0xf bank_mask:0xf
  v_dot2c_f32_bf16_dpp v8, v28, v124 row_newbcast:7 row_mask:0xf bank_mask:0xf
  v_dot2c_f32_bf16_dpp v9, v29, v124 row_newbcast:7 row_mask:0xf bank_mask:0xf
  v_dot2c_f32_bf16_dpp v10, v28, v125 row_newbcast:7 row_mask:0xf bank_mask:0xf
  v_dot2c_f32_bf16_dpp v11, v29, v125 row_newbcast:7 row_mask:0xf bank_mask:0xf
  v_dot2c_f32_bf16_dpp v12, v28, v126 row_newbcast:7 row_mask:0xf bank_mask:0xf
  v_dot2c_f32_bf16_dpp v13, v29, v126 row_newbcast:7 row_mask:0xf bank_mask:0xf
  v_dot2c_f32_bf16_dpp v14, v28, v127 row_newbcast:7 row_mask:0xf bank_mask:0xf
  v_dot2c_f32_bf16_dpp v15, v29, v127 row_newbcast:7 row_mask:0xf bank_mask:0xf
  v_permlane32_swap_b32 v8, v12
  s_nop 0
  v_permlane32_swap_b32 v10, v14
  v_permlane32_swap_b32 v9, v13
  v_permlane32_swap_b32 v11, v15
  v_add_f32 v8, v8, v12
  v_add_f32 v10, v10, v14
  v_add_f32 v9, v9, v13
  v_add_f32 v11, v11, v15
  v_permlane16_swap_b32 v8, v10
  s_nop 0
  v_permlane16_swap_b32 v9, v11
  v_add_f32 v8, v8, v10
  v_add_f32 v9, v9, v11
  ds_write_b64 v240, v[8:9] offset:6528
  v_mov_b32 v10, 0
  v_mov_b32 v11, 0
  v_mov_b32 v12, 0
  v_mov_b32 v13, 0
  v_mov_b32 v14, 0
  v_mov_b32 v15, 0
  s_waitcnt lgkmcnt(0)
  s_barrier
  v_mov_b32 v8, 0
  v_mov_b32 v9, 0
  s_branch L_dp_w
L_dp:
  buffer_load_dwordx4 v[32:35], v4, s[64:67], s31 offen sc1
  s_add_u32 s93, s31, 4096
  buffer_load_dwordx4 v[36:39], v4, s[64:67], s93 offen sc1
  s_add_u32 s93, s31, 8192
  buffer_load_dwordx4 v[40:43], v4, s[64:67], s93 offen sc1
  s_add_u32 s93, s31, 12288
  buffer_load_dwordx4 v[44:47], v4, s[64:67], s93 offen sc1
L_dp_w:
  s_waitcnt vmcnt(0)
  v_max3_u32 v5, v32, v33, v34
  v_max3_u32 v5, v5, v35, v36
  v_max3_u32 v5, v5, v37, v38
  v_max3_u32 v5, v5, v39, v40
  v_max3_u32 v5, v5, v41, v42
  v_max3_u32 v5, v5, v43, v44
  v_max3_u32 v5, v5, v45, v46
  v_max_u32 v5, v5, v47
  v_max3_f32 v16, v34, v38, v42
  v_cmp_eq_u32 vcc, -1, v5
  v_max_f32 v16, v16, v46
  s_sub_u32 s94, s94, 1
  s_cbranch_scc1 L_dp_ok
  s_cbranch_vccnz L_dp
L_dp_ok:
  v_max_f32_dpp v16, v16, v16 row_ror:8 row_mask:0xf bank_mask:0xf
  v_cndmask_b32 v32, v32, v33, s[76:77]
  v_cndmask_b32 v36, v36, v37, s[76:77]
  v_cndmask_b32 v40, v40, v41, s[76:77]
  v_cndmask_b32 v44, v44, v45, s[76:77]
  v_sub_f32 v34, v34, v16
  v_sub_f32 v38, v38, v16
  v_sub_f32 v42, v42, v16
  v_sub_f32 v46, v46, v16
  v_exp_f32 v34, v34
  v_exp_f32 v38, v38
  v_exp_f32 v42, v42
  v_exp_f32 v46, v46
  v_mul_f32 v6, v34, v35
  v_mul_f32 v7, v34, v32
  v_fmac_f32 v6, v38, v39
  v_fmac_f32 v7, v38, v36
  v_fmac_f32 v6, v42, v43
  v_fmac_f32 v7, v42, v40
  v_fmac_f32 v6, v46, v47
  v_fmac_f32 v7, v46, v44
  s_nop 0
  v_add_f32_dpp v6, v6, v6 row_ror:8 row_mask:0xf bank_mask:0xf
  v_add_f32_dpp v7, v7, v7 row_ror:8 row_mask:0xf bank_mask:0xf
  v_rcp_f32 v6, v6
  s_nop 0
  v_mul_f32 v7, v7, v6
  v_cvt_pk_bf16_f32 v28, v7, 0
  v_lshlrev_b32 v29, 16, v28
  s_nop 0
  v_dot2c_f32_bf16_dpp v8, v28, v64 row_newbcast:0 row_mask:0xf bank_mask:0xf
  v_dot2c_f32_bf16_dpp v9, v29, v64 row_newbcast:0 row_mask:0xf bank_mask:0xf
  v_dot2c_f32_bf16_dpp v10, v28, v65 row_newbcast:0 row_mask:0xf bank_mask:0xf
  v_dot2c_f32_bf16_dpp v11, v29, v65 row_newbcast:0 row_mask:0xf bank_mask:0xf
  v_dot2c_f32_bf16_dpp v12, v28, v66 row_newbcast:0 row_mask:0xf bank_mask:0xf
  v_dot2c_f32_bf16_dpp v13, v29, v66 row_newbcast:0 row_mask:0xf bank_mask:0xf
  v_dot2c_f32_bf16_dpp v14, v28, v67 row_newbcast:0 row_mask:0xf bank_mask:0xf
  v_dot2c_f32_bf16_dpp v15, v29, v67 row_newbcast:0 row_mask:0xf bank_mask:0xf
  v_dot2c_f32_bf16_dpp v8, v28, v68 row_newbcast:1 row_mask:0xf bank_mask:0xf
  v_dot2c_f32_bf16_dpp v9, v29, v68 row_newbcast:1 row_mask:0xf bank_mask:0xf
  v_dot2c_f32_bf16_dpp v10, v28, v69 row_newbcast:1 row_mask:0xf bank_mask:0xf
  v_dot2c_f32_bf16_dpp v11, v29, v69 row_newbcast:1 row_mask:0xf bank_mask:0xf
  v_dot2c_f32_bf16_dpp v12, v28, v70 row_newbcast:1 row_mask:0xf bank_mask:0xf
  v_dot2c_f32_bf16_dpp v13, v29, v70 row_newbcast:1 row_mask:0xf bank_mask:0xf
  v_dot2c_f32_bf16_dpp v14, v28, v71 row_newbcast:1 row_mask:0xf bank_mask:0xf
  v_dot2c_f32_bf16_dpp v15, v29, v71 row_newbcast:1 row_mask:0xf bank_mask:0xf
  v_dot2c_f32_bf16_dpp v8, v28, v72 row_newbcast:2 row_mask:0xf bank_mask:0xf
  v_dot2c_f32_bf16_dpp v9, v29, v72 row_newbcast:2 row_mask:0xf bank_mask:0xf
  v_dot2c_f32_bf16_dpp v10, v28, v73 row_newbcast:2 row_mask:0xf bank_mask:0xf
  v_dot2c_f32_bf16_dpp v11, v29, v73 row_newbcast:2 row_mask:0xf bank_mask:0xf
  v_dot2c_f32_bf16_dpp v12, v28, v74 row_newbcast:2 row_mask:0xf bank_mask:0xf
  v_dot2c_f32_bf16_dpp v13, v29, v74 row_newbcast:2 row_mask:0xf bank_mask:0xf
  v_dot2c_f32_bf16_dpp v14, v28, v75 row_newbcast:2 row_mask:0xf bank_mask:0xf
  v_dot2c_f32_bf16_dpp v15, v29, v75 row_newbcast:2 row_mask:0xf bank_mask:0xf
  v_dot2c_f32_bf16_dpp v8, v28, v76 row_newbcast:3 row_mask:0xf bank_mask:0xf
  v_dot2c_f32_bf16_dpp v9, v29, v76 row_newbcast:3 row_mask:0xf bank_mask:0xf
  v_dot2c_f32_bf16_dpp v10, v28, v77 row_newbcast:3 row_mask:0xf bank_mask:0xf
  v_dot2c_f32_bf16_dpp v11, v29, v77 row_newbcast:3 row_mask:0xf bank_mask:0xf
  v_dot2c_f32_bf16_dpp v12, v28, v78 row_newbcast:3 row_mask:0xf bank_mask:0xf
  v_dot2c_f32_bf16_dpp v13, v29, v78 row_newbcast:3 row_mask:0xf bank_mask:0xf
  v_dot2c_f32_bf16_dpp v14, v28, v79 row_newbcast:3 row_mask:0xf bank_mask:0xf
  v_dot2c_f32_bf16_dpp v15, v29, v79 row_newbcast:3 row_mask:0xf bank_mask:0xf
  v_dot2c_f32_bf16_dpp v8, v28, v80 row_newbcast:4 row_mask:0xf bank_mask:0xf
  v_dot2c_f32_bf16_dpp v9, v29, v80 row_newbcast:4 row_mask:0xf bank_mask:0xf
  v_dot2c_f32_bf16_dpp v10, v28, v81 row_newbcast:4 row_mask:0xf bank_mask:0xf
  v_dot2c_f32_bf16_dpp v11, v29, v81 row_newbcast:4 row_mask:0xf bank_mask:0xf
  v_dot2c_f32_bf16_dpp v12, v28, v82 row_newbcast:4 row_mask:0xf bank_mask:0xf
  v_dot2c_f32_bf16_dpp v13, v29, v82 row_newbcast:4 row_mask:0xf bank_mask:0xf
  v_dot2c_f32_bf16_dpp v14, v28, v83 row_newbcast:4 row_mask:0xf bank_mask:0xf
  v_dot2c_f32_bf16_dpp v15, v29, v83 row_newbcast:4 row_mask:0xf bank_mask:0xf
  v_dot2c_f32_bf16_dpp v8, v28, v84 row_newbcast:5 row_mask:0xf bank_mask:0xf
  v_dot2c_f32_bf16_dpp v9, v29, v84 row_newbcast:5 row_mask:0xf bank_mask:0xf
  v_dot2c_f32_bf16_dpp v10, v28, v85 row_newbcast:5 row_mask:0xf bank_mask:0xf
  v_dot2c_f32_bf16_dpp v11, v29, v85 row_newbcast:5 row_mask:0xf bank_mask:0xf
  v_dot2c_f32_bf16_dpp v12, v28, v86 row_newbcast:5 row_mask:0xf bank_mask:0xf
  v_dot2c_f32_bf16_dpp v13, v29, v86 row_newbcast:5 row_mask:0xf bank_mask:0xf
  v_dot2c_f32_bf16_dpp v14, v28, v87 row_newbcast:5 row_mask:0xf bank_mask:0xf
  v_dot2c_f32_bf16_dpp v15, v29, v87 row_newbcast:5 row_mask:0xf bank_mask:0xf
  v_dot2c_f32_bf16_dpp v8, v28, v88 row_newbcast:6 row_mask:0xf bank_mask:0xf
  v_dot2c_f32_bf16_dpp v9, v29, v88 row_newbcast:6 row_mask:0xf bank_mask:0xf
  v_dot2c_f32_bf16_dpp v10, v28, v89 row_newbcast:6 row_mask:0xf bank_mask:0xf
  v_dot2c_f32_bf16_dpp v11, v29, v89 row_newbcast:6 row_mask:0xf bank_mask:0xf
  v_dot2c_f32_bf16_dpp v12, v28, v90 row_newbcast:6 row_mask:0xf bank_mask:0xf
  v_dot2c_f32_bf16_dpp v13, v29, v90 row_newbcast:6 row_mask:0xf bank_mask:0xf
  v_dot2c_f32_bf16_dpp v14, v28, v91 row_newbcast:6 row_mask:0xf bank_mask:0xf
  v_dot2c_f32_bf16_dpp v15, v29, v91 row_newbcast:6 row_mask:0xf bank_mask:0xf
  v_dot2c_f32_bf16_dpp v8, v28, v92 row_newbcast:7 row_mask:0xf bank_mask:0xf
  v_dot2c_f32_bf16_dpp v9, v29, v92 row_newbcast:7 row_mask:0xf bank_mask:0xf
  v_dot2c_f32_bf16_dpp v10, v28, v93 row_newbcast:7 row_mask:0xf bank_mask:0xf
  v_dot2c_f32_bf16_dpp v11, v29, v93 row_newbcast:7 row_mask:0xf bank_mask:0xf
  v_dot2c_f32_bf16_dpp v12, v28, v94 row_newbcast:7 row_mask:0xf bank_mask:0xf
  v_dot2c_f32_bf16_dpp v13, v29, v94 row_newbcast:7 row_mask:0xf bank_mask:0xf
  v_dot2c_f32_bf16_dpp v14, v28, v95 row_newbcast:7 row_mask:0xf bank_mask:0xf
  v_dot2c_f32_bf16_dpp v15, v29, v95 row_newbcast:7 row_mask:0xf bank_mask:0xf
  v_permlane32_swap_b32 v8, v12
  s_nop 0
  v_permlane32_swap_b32 v10, v14
  v_permlane32_swap_b32 v9, v13
  v_permlane32_swap_b32 v11, v15
  v_add_f32 v8, v8, v12
  v_add_f32 v10, v10, v14
  v_add_f32 v9, v9, v13
  v_add_f32 v11, v11, v15
  v_permlane16_swap_b32 v8, v10
  s_nop 0
  v_permlane16_swap_b32 v9, v11
  v_add_f32 v8, v8, v10
  v_add_f32 v9, v9, v11
  ds_write_b64 v240, v[8:9] offset:8704
  s_waitcnt lgkmcnt(0)
  s_barrier
  s_endpgm
L_event:
  s_barrier
  ds_read_b128 v[128:131], v249 offset:29056
  ds_read_b128 v[132:135], v249 offset:29312
  ds_read_b128 v[136:139], v249 offset:29568
  ds_read_b128 v[140:143], v249 offset:29824
  ds_read_b128 v[144:147], v249 offset:30080
  ds_read_b128 v[148:151], v249 offset:30336
  ds_read_b128 v[152:155], v249 offset:30592
  ds_read_b128 v[156:159], v249 offset:30848
  v_mov_b32 v112, 0xff7fffff
  v_mov_b32 v232, 0
  v_mov_b32 v113, 0xff7fffff
  v_mov_b32 v233, 0
  v_mov_b32 v114, 0xff7fffff
  v_mov_b32 v234, 0
  v_mov_b32 v115, 0xff7fffff
  v_mov_b32 v235, 0
  v_mov_b32 v116, 0xff7fffff
  v_mov_b32 v236, 0
  v_mov_b32 v117, 0xff7fffff
  v_mov_b32 v237, 0
  v_mov_b32 v118, 0xff7fffff
  v_mov_b32 v238, 0
  v_mov_b32 v119, 0xff7fffff
  v_mov_b32 v239, 0
  v_mov_b32 v248, v251
  s_mov_b32 s31, 4
  s_waitcnt lgkmcnt(0)
L_ak:
  s_sub_u32 s31, s31, 1
  s_add_u32 s25, s87, 32768
  s_cmp_eq_u32 s31, 0
  s_cselect_b32 s12, s60, s56
  s_cselect_b32 s13, s61, s57
  s_cselect_b32 s25, s30, s25
  s_waitcnt vmcnt(4)
  buffer_load_dwordx4 v[52:55], v31, s[56:59], s87 offen offset:1024 nt
  buffer_load_dwordx4 v[56:59], v31, s[56:59], s87 offen offset:2048 nt
  v_dot2_f32_bf16 v64, v32, v128, 0
  v_dot2_f32_bf16 v68, v32, v132, 0
  v_dot2_f32_bf16 v72, v32, v136, 0
  v_dot2_f32_bf16 v76, v32, v140, 0
  v_dot2_f32_bf16 v80, v32, v144, 0
  v_dot2_f32_bf16 v84, v32, v148, 0
  v_dot2_f32_bf16 v88, v32, v152, 0
  v_dot2_f32_bf16 v92, v32, v156, 0
  v_dot2_f32_bf16 v64, v33, v129, v64
  v_dot2_f32_bf16 v68, v33, v133, v68
  v_dot2_f32_bf16 v72, v33, v137, v72
  v_dot2_f32_bf16 v76, v33, v141, v76
  v_dot2_f32_bf16 v80, v33, v145, v80
  v_dot2_f32_bf16 v84, v33, v149, v84
  v_dot2_f32_bf16 v88, v33, v153, v88
  v_dot2_f32_bf16 v92, v33, v157, v92
  v_dot2_f32_bf16 v64, v34, v130, v64
  v_dot2_f32_bf16 v68, v34, v134, v68
  v_dot2_f32_bf16 v72, v34, v138, v72
  v_dot2_f32_bf16 v76, v34, v142, v76
  v_dot2_f32_bf16 v80, v34, v146, v80
  v_dot2_f32_bf16 v84, v34, v150, v84
  v_dot2_f32_bf16 v88, v34, v154, v88
  v_dot2_f32_bf16 v92, v34, v158, v92
  v_dot2_f32_bf16 v64, v35, v131, v64
  v_dot2_f32_bf16 v68, v35, v135, v68
  v_dot2_f32_bf16 v72, v35, v139, v72
  v_dot2_f32_bf16 v76, v35, v143, v76
  v_dot2_f32_bf16 v80, v35, v147, v80
  v_dot2_f32_bf16 v84, v35, v151, v84
  v_dot2_f32_bf16 v88, v35, v155, v88
  v_dot2_f32_bf16 v92, v35, v159, v92
  s_waitcnt vmcnt(5)
  buffer_load_dwordx4 v[60:63], v31, s[56:59], s87 offen offset:3072 nt
  buffer_load_dwordx4 v[32:35], v1, s[12:15], s25 offen offset:0 nt
  v_dot2_f32_bf16 v65, v36, v128, 0
  v_dot2_f32_bf16 v69, v36, v132, 0
  v_dot2_f32_bf16 v73, v36, v136, 0
  v_dot2_f32_bf16 v77, v36, v140, 0
  v_dot2_f32_bf16 v81, v36, v144, 0
  v_dot2_f32_bf16 v85, v36, v148, 0
  v_dot2_f32_bf16 v89, v36, v152, 0
  v_dot2_f32_bf16 v93, v36, v156, 0
  v_dot2_f32_bf16 v65, v37, v129, v65
  v_dot2_f32_bf16 v69, v37, v133, v69
  v_dot2_f32_bf16 v73, v37, v137, v73
  v_dot2_f32_bf16 v77, v37, v141, v77
  v_dot2_f32_bf16 v81, v37, v145, v81
  v_dot2_f32_bf16 v85, v37, v149, v85
  v_dot2_f32_bf16 v89, v37, v153, v89
  v_dot2_f32_bf16 v93, v37, v157, v93
  v_dot2_f32_bf16 v65, v38, v130, v65
  v_dot2_f32_bf16 v69, v38, v134, v69
  v_dot2_f32_bf16 v73, v38, v138, v73
  v_dot2_f32_bf16 v77, v38, v142, v77
  v_dot2_f32_bf16 v81, v38, v146, v81
  v_dot2_f32_bf16 v85, v38, v150, v85
  v_dot2_f32_bf16 v89, v38, v154, v89
  v_dot2_f32_bf16 v93, v38, v158, v93
  v_dot2_f32_bf16 v65, v39, v131, v65
  v_dot2_f32_bf16 v69, v39, v135, v69
  v_dot2_f32_bf16 v73, v39, v139, v73
  v_dot2_f32_bf16 v77, v39, v143, v77
  v_dot2_f32_bf16 v81, v39, v147, v81
  v_dot2_f32_bf16 v85, v39, v151, v85
  v_dot2_f32_bf16 v89, v39, v155, v89
  v_dot2_f32_bf16 v93, v39, v159, v93
  s_waitcnt vmcnt(6)
  buffer_load_dwordx4 v[36:39], v1, s[12:15], s25 offen offset:1024 nt
  v_dot2_f32_bf16 v66, v40, v128, 0
  v_dot2_f32_bf16 v70, v40, v132, 0
  v_dot2_f32_bf16 v74, v40, v136, 0
  v_dot2_f32_bf16 v78, v40, v140, 0
  v_dot2_f32_bf16 v82, v40, v144, 0
  v_dot2_f32_bf16 v86, v40, v148, 0
  v_dot2_f32_bf16 v90, v40, v152, 0
  v_dot2_f32_bf16 v94, v40, v156, 0
  v_dot2_f32_bf16 v66, v41, v129, v66
  v_dot2_f32_bf16 v70, v41, v133, v70
  v_dot2_f32_bf16 v74, v41, v137, v74
  v_dot2_f32_bf16 v78, v41, v141, v78
  v_dot2_f32_bf16 v82, v41, v145, v82
  v_dot2_f32_bf16 v86, v41, v149, v86
  v_dot2_f32_bf16 v90, v41, v153, v90
  v_dot2_f32_bf16 v94, v41, v157, v94
  v_dot2_f32_bf16 v66, v42, v130, v66
  v_dot2_f32_bf16 v70, v42, v134, v70
  v_dot2_f32_bf16 v74, v42, v138, v74
  v_dot2_f32_bf16 v78, v42, v142, v78
  v_dot2_f32_bf16 v82, v42, v146, v82
  v_dot2_f32_bf16 v86, v42, v150, v86
  v_dot2_f32_bf16 v90, v42, v154, v90
  v_dot2_f32_bf16 v94, v42, v158, v94
  v_dot2_f32_bf16 v66, v43, v131, v66
  v_dot2_f32_bf16 v70, v43, v135, v70
  v_dot2_f32_bf16 v74, v43, v139, v74
  v_dot2_f32_bf16 v78, v43, v143, v78
  v_dot2_f32_bf16 v82, v43, v147, v82
  v_dot2_f32_bf16 v86, v43, v151, v86
  v_dot2_f32_bf16 v90, v43, v155, v90
  v_dot2_f32_bf16 v94, v43, v159, v94
  s_waitcnt vmcnt(6)
  buffer_load_dwordx4 v[40:43], v1, s[12:15], s25 offen offset:2048 nt
  v_dot2_f32_bf16 v67, v44, v128, 0
  v_dot2_f32_bf16 v71, v44, v132, 0
  v_dot2_f32_bf16 v75, v44, v136, 0
  v_dot2_f32_bf16 v79, v44, v140, 0
  v_dot2_f32_bf16 v83, v44, v144, 0
  v_dot2_f32_bf16 v87, v44, v148, 0
  v_dot2_f32_bf16 v91, v44, v152, 0
  v_dot2_f32_bf16 v95, v44, v156, 0
  v_dot2_f32_bf16 v67, v45, v129, v67
  v_dot2_f32_bf16 v71, v45, v133, v71
  v_dot2_f32_bf16 v75, v45, v137, v75
  v_dot2_f32_bf16 v79, v45, v141, v79
  v_dot2_f32_bf16 v83, v45, v145, v83
  v_dot2_f32_bf16 v87, v45, v149, v87
  v_dot2_f32_bf16 v91, v45, v153, v91
  v_dot2_f32_bf16 v95, v45, v157, v95
  v_dot2_f32_bf16 v67, v46, v130, v67
  v_dot2_f32_bf16 v71, v46, v134, v71
  v_dot2_f32_bf16 v75, v46, v138, v75
  v_dot2_f32_bf16 v79, v46, v142, v79
  v_dot2_f32_bf16 v83, v46, v146, v83
  v_dot2_f32_bf16 v87, v46, v150, v87
  v_dot2_f32_bf16 v91, v46, v154, v91
  v_dot2_f32_bf16 v95, v46, v158, v95
  v_dot2_f32_bf16 v67, v47, v131, v67
  v_dot2_f32_bf16 v71, v47, v135, v71
  v_dot2_f32_bf16 v75, v47, v139, v75
  v_dot2_f32_bf16 v79, v47, v143, v79
  v_dot2_f32_bf16 v83, v47, v147, v83
  v_dot2_f32_bf16 v87, v47, v151, v87
  v_dot2_f32_bf16 v91, v47, v155, v91
  v_dot2_f32_bf16 v95, v47, v159, v95
  v_add_f32_dpp v96, v64, v64 row_ror:8 row_mask:0xf bank_mask:0x3
  v_add_f32_dpp v98, v68, v68 row_ror:8 row_mask:0xf bank_mask:0x3
  v_add_f32_dpp v100, v72, v72 row_ror:8 row_mask:0xf bank_mask:0x3
  v_add_f32_dpp v102, v76, v76 row_ror:8 row_mask:0xf bank_mask:0x3
  v_add_f32_dpp v104, v80, v80 row_ror:8 row_mask:0xf bank_mask:0x3
  v_add_f32_dpp v106, v84, v84 row_ror:8 row_mask:0xf bank_mask:0x3
  v_add_f32_dpp v108, v88, v88 row_ror:8 row_mask:0xf bank_mask:0x3
  v_add_f32_dpp v110, v92, v92 row_ror:8 row_mask:0xf bank_mask:0x3
  v_add_f32_dpp v97, v66, v66 row_ror:8 row_mask:0xf bank_mask:0x3
  v_add_f32_dpp v99, v70, v70 row_ror:8 row_mask:0xf bank_mask:0x3
  v_add_f32_dpp v101, v74, v74 row_ror:8 row_mask:0xf bank_mask:0x3
  v_add_f32_dpp v103, v78, v78 row_ror:8 row_mask:0xf bank_mask:0x3
  v_add_f32_dpp v105, v82, v82 row_ror:8 row_mask:0xf bank_mask:0x3
  v_add_f32_dpp v107, v86, v86 row_ror:8 row_mask:0xf bank_mask:0x3
  v_add_f32_dpp v109, v90, v90 row_ror:8 row_mask:0xf bank_mask:0x3
  v_add_f32_dpp v111, v94, v94 row_ror:8 row_mask:0xf bank_mask:0x3
  v_add_f32_dpp v96, v65, v65 row_ror:8 row_mask:0xf bank_mask:0xc
  v_add_f32_dpp v98, v69, v69 row_ror:8 row_mask:0xf bank_mask:0xc
  v_add_f32_dpp v100, v73, v73 row_ror:8 row_mask:0xf bank_mask:0xc
  v_add_f32_dpp v102, v77, v77 row_ror:8 row_mask:0xf bank_mask:0xc
  v_add_f32_dpp v104, v81, v81 row_ror:8 row_mask:0xf bank_mask:0xc
  v_add_f32_dpp v106, v85, v85 row_ror:8 row_mask:0xf bank_mask:0xc
  v_add_f32_dpp v108, v89, v89 row_ror:8 row_mask:0xf bank_mask:0xc
  v_add_f32_dpp v110, v93, v93 row_ror:8 row_mask:0xf bank_mask:0xc
  v_add_f32_dpp v97, v67, v67 row_ror:8 row_mask:0xf bank_mask:0xc
  v_add_f32_dpp v99, v71, v71 row_ror:8 row_mask:0xf bank_mask:0xc
  v_add_f32_dpp v101, v75, v75 row_ror:8 row_mask:0xf bank_mask:0xc
  v_add_f32_dpp v103, v79, v79 row_ror:8 row_mask:0xf bank_mask:0xc
  v_add_f32_dpp v105, v83, v83 row_ror:8 row_mask:0xf bank_mask:0xc
  v_add_f32_dpp v107, v87, v87 row_ror:8 row_mask:0xf bank_mask:0xc
  v_add_f32_dpp v109, v91, v91 row_ror:8 row_mask:0xf bank_mask:0xc
  v_add_f32_dpp v111, v95, v95 row_ror:8 row_mask:0xf bank_mask:0xc
  v_add_f32_dpp v120, v96, v96 row_half_mirror row_mask:0xf bank_mask:0x5
  v_add_f32_dpp v121, v98, v98 row_half_mirror row_mask:0xf bank_mask:0x5
  v_add_f32_dpp v122, v100, v100 row_half_mirror row_mask:0xf bank_mask:0x5
  v_add_f32_dpp v123, v102, v102 row_half_mirror row_mask:0xf bank_mask:0x5
  v_add_f32_dpp v124, v104, v104 row_half_mirror row_mask:0xf bank_mask:0x5
  v_add_f32_dpp v125, v106, v106 row_half_mirror row_mask:0xf bank_mask:0x5
  v_add_f32_dpp v126, v108, v108 row_half_mirror row_mask:0xf bank_mask:0x5
  v_add_f32_dpp v127, v110, v110 row_half_mirror row_mask:0xf bank_mask:0x5
  v_add_f32_dpp v120, v97, v97 row_half_mirror row_mask:0xf bank_mask:0xa
  v_add_f32_dpp v121, v99, v99 row_half_mirror row_mask:0xf bank_mask:0xa
  v_add_f32_dpp v122, v101, v101 row_half_mirror row_mask:0xf bank_mask:0xa
  v_add_f32_dpp v123, v103, v103 row_half_mirror row_mask:0xf bank_mask:0xa
  v_add_f32_dpp v124, v105, v105 row_half_mirror row_mask:0xf bank_mask:0xa
  v_add_f32_dpp v125, v107, v107 row_half_mirror row_mask:0xf bank_mask:0xa
  v_add_f32_dpp v126, v109, v109 row_half_mirror row_mask:0xf bank_mask:0xa
  v_add_f32_dpp v127, v111, v111 row_half_mirror row_mask:0xf bank_mask:0xa
  v_add_f32_dpp v120, v120, v120 quad_perm:[1,0,3,2] row_mask:0xf bank_mask:0xf
  v_add_f32_dpp v121, v121, v121 quad_perm:[1,0,3,2] row_mask:0xf bank_mask:0xf
  v_add_f32_dpp v122, v122, v122 quad_perm:[1,0,3,2] row_mask:0xf bank_mask:0xf
  v_add_f32_dpp v123, v123, v123 quad_perm:[1,0,3,2] row_mask:0xf bank_mask:0xf
  v_add_f32_dpp v124, v124, v124 quad_perm:[1,0,3,2] row_mask:0xf bank_mask:0xf
  v_add_f32_dpp v125, v125, v125 quad_perm:[1,0,3,2] row_mask:0xf bank_mask:0xf
  v_add_f32_dpp v126, v126, v126 quad_perm:[1,0,3,2] row_mask:0xf bank_mask:0xf
  v_add_f32_dpp v127, v127, v127 quad_perm:[1,0,3,2] row_mask:0xf bank_mask:0xf
  v_add_f32_dpp v120, v120, v120 quad_perm:[2,3,0,1] row_mask:0xf bank_mask:0xf
  v_add_f32_dpp v121, v121, v121 quad_perm:[2,3,0,1] row_mask:0xf bank_mask:0xf
  v_add_f32_dpp v122, v122, v122 quad_perm:[2,3,0,1] row_mask:0xf bank_mask:0xf
  v_add_f32_dpp v123, v123, v123 quad_perm:[2,3,0,1] row_mask:0xf bank_mask:0xf
  v_add_f32_dpp v124, v124, v124 quad_perm:[2,3,0,1] row_mask:0xf bank_mask:0xf
  v_add_f32_dpp v125, v125, v125 quad_perm:[2,3,0,1] row_mask:0xf bank_mask:0xf
  v_add_f32_dpp v126, v126, v126 quad_perm:[2,3,0,1] row_mask:0xf bank_mask:0xf
  v_add_f32_dpp v127, v127, v127 quad_perm:[2,3,0,1] row_mask:0xf bank_mask:0xf
  v_max_f32 v112, v112, v120
  ds_write_b32 v248, v120 offset:4096
  v_max_f32 v113, v113, v121
  ds_write_b32 v248, v121 offset:4224
  v_max_f32 v114, v114, v122
  ds_write_b32 v248, v122 offset:4352
  v_max_f32 v115, v115, v123
  ds_write_b32 v248, v123 offset:4480
  v_max_f32 v116, v116, v124
  ds_write_b32 v248, v124 offset:4608
  v_max_f32 v117, v117, v125
  ds_write_b32 v248, v125 offset:4736
  v_max_f32 v118, v118, v126
  ds_write_b32 v248, v126 offset:4864
  v_max_f32 v119, v119, v127
  ds_write_b32 v248, v127 offset:4992
  s_waitcnt vmcnt(6)
  buffer_load_dwordx4 v[44:47], v1, s[12:15], s25 offen offset:3072 nt
  v_dot2_f32_bf16 v64, v48, v128, 0
  v_dot2_f32_bf16 v68, v48, v132, 0
  v_dot2_f32_bf16 v72, v48, v136, 0
  v_dot2_f32_bf16 v76, v48, v140, 0
  v_dot2_f32_bf16 v80, v48, v144, 0
  v_dot2_f32_bf16 v84, v48, v148, 0
  v_dot2_f32_bf16 v88, v48, v152, 0
  v_dot2_f32_bf16 v92, v48, v156, 0
  v_dot2_f32_bf16 v64, v49, v129, v64
  v_dot2_f32_bf16 v68, v49, v133, v68
  v_dot2_f32_bf16 v72, v49, v137, v72
  v_dot2_f32_bf16 v76, v49, v141, v76
  v_dot2_f32_bf16 v80, v49, v145, v80
  v_dot2_f32_bf16 v84, v49, v149, v84
  v_dot2_f32_bf16 v88, v49, v153, v88
  v_dot2_f32_bf16 v92, v49, v157, v92
  v_dot2_f32_bf16 v64, v50, v130, v64
  v_dot2_f32_bf16 v68, v50, v134, v68
  v_dot2_f32_bf16 v72, v50, v138, v72
  v_dot2_f32_bf16 v76, v50, v142, v76
  v_dot2_f32_bf16 v80, v50, v146, v80
  v_dot2_f32_bf16 v84, v50, v150, v84
  v_dot2_f32_bf16 v88, v50, v154, v88
  v_dot2_f32_bf16 v92, v50, v158, v92
  v_dot2_f32_bf16 v64, v51, v131, v64
  v_dot2_f32_bf16 v68, v51, v135, v68
  v_dot2_f32_bf16 v72, v51, v139, v72
  v_dot2_f32_bf16 v76, v51, v143, v76
  v_dot2_f32_bf16 v80, v51, v147, v80
  v_dot2_f32_bf16 v84, v51, v151, v84
  v_dot2_f32_bf16 v88, v51, v155, v88
  v_dot2_f32_bf16 v92, v51, v159, v92
  s_waitcnt vmcnt(6)
  buffer_load_dwordx4 v[48:51], v31, s[12:15], s25 offen offset:0 nt
  v_dot2_f32_bf16 v65, v52, v128, 0
  v_dot2_f32_bf16 v69, v52, v132, 0
  v_dot2_f32_bf16 v73, v52, v136, 0
  v_dot2_f32_bf16 v77, v52, v140, 0
  v_dot2_f32_bf16 v81, v52, v144, 0
  v_dot2_f32_bf16 v85, v52, v148, 0
  v_dot2_f32_bf16 v89, v52, v152, 0
  v_dot2_f32_bf16 v93, v52, v156, 0
  v_dot2_f32_bf16 v65, v53, v129, v65
  v_dot2_f32_bf16 v69, v53, v133, v69
  v_dot2_f32_bf16 v73, v53, v137, v73
  v_dot2_f32_bf16 v77, v53, v141, v77
  v_dot2_f32_bf16 v81, v53, v145, v81
  v_dot2_f32_bf16 v85, v53, v149, v85
  v_dot2_f32_bf16 v89, v53, v153, v89
  v_dot2_f32_bf16 v93, v53, v157, v93
  v_dot2_f32_bf16 v65, v54, v130, v65
  v_dot2_f32_bf16 v69, v54, v134, v69
  v_dot2_f32_bf16 v73, v54, v138, v73
  v_dot2_f32_bf16 v77, v54, v142, v77
  v_dot2_f32_bf16 v81, v54, v146, v81
  v_dot2_f32_bf16 v85, v54, v150, v85
  v_dot2_f32_bf16 v89, v54, v154, v89
  v_dot2_f32_bf16 v93, v54, v158, v93
  v_dot2_f32_bf16 v65, v55, v131, v65
  v_dot2_f32_bf16 v69, v55, v135, v69
  v_dot2_f32_bf16 v73, v55, v139, v73
  v_dot2_f32_bf16 v77, v55, v143, v77
  v_dot2_f32_bf16 v81, v55, v147, v81
  v_dot2_f32_bf16 v85, v55, v151, v85
  v_dot2_f32_bf16 v89, v55, v155, v89
  v_dot2_f32_bf16 v93, v55, v159, v93
  s_waitcnt vmcnt(6)
  v_dot2_f32_bf16 v66, v56, v128, 0
  v_dot2_f32_bf16 v70, v56, v132, 0
  v_dot2_f32_bf16 v74, v56, v136, 0
  v_dot2_f32_bf16 v78, v56, v140, 0
  v_dot2_f32_bf16 v82, v56, v144, 0
  v_dot2_f32_bf16 v86, v56, v148, 0
  v_dot2_f32_bf16 v90, v56, v152, 0
  v_dot2_f32_bf16 v94, v56, v156, 0
  v_dot2_f32_bf16 v66, v57, v129, v66
  v_dot2_f32_bf16 v70, v57, v133, v70
  v_dot2_f32_bf16 v74, v57, v137, v74
  v_dot2_f32_bf16 v78, v57, v141, v78
  v_dot2_f32_bf16 v82, v57, v145, v82
  v_dot2_f32_bf16 v86, v57, v149, v86
  v_dot2_f32_bf16 v90, v57, v153, v90
  v_dot2_f32_bf16 v94, v57, v157, v94
  v_dot2_f32_bf16 v66, v58, v130, v66
  v_dot2_f32_bf16 v70, v58, v134, v70
  v_dot2_f32_bf16 v74, v58, v138, v74
  v_dot2_f32_bf16 v78, v58, v142, v78
  v_dot2_f32_bf16 v82, v58, v146, v82
  v_dot2_f32_bf16 v86, v58, v150, v86
  v_dot2_f32_bf16 v90, v58, v154, v90
  v_dot2_f32_bf16 v94, v58, v158, v94
  v_dot2_f32_bf16 v66, v59, v131, v66
  v_dot2_f32_bf16 v70, v59, v135, v70
  v_dot2_f32_bf16 v74, v59, v139, v74
  v_dot2_f32_bf16 v78, v59, v143, v78
  v_dot2_f32_bf16 v82, v59, v147, v82
  v_dot2_f32_bf16 v86, v59, v151, v86
  v_dot2_f32_bf16 v90, v59, v155, v90
  v_dot2_f32_bf16 v94, v59, v159, v94
  s_waitcnt vmcnt(5)
  v_dot2_f32_bf16 v67, v60, v128, 0
  v_dot2_f32_bf16 v71, v60, v132, 0
  v_dot2_f32_bf16 v75, v60, v136, 0
  v_dot2_f32_bf16 v79, v60, v140, 0
  v_dot2_f32_bf16 v83, v60, v144, 0
  v_dot2_f32_bf16 v87, v60, v148, 0
  v_dot2_f32_bf16 v91, v60, v152, 0
  v_dot2_f32_bf16 v95, v60, v156, 0
  v_dot2_f32_bf16 v67, v61, v129, v67
  v_dot2_f32_bf16 v71, v61, v133, v71
  v_dot2_f32_bf16 v75, v61, v137, v75
  v_dot2_f32_bf16 v79, v61, v141, v79
  v_dot2_f32_bf16 v83, v61, v145, v83
  v_dot2_f32_bf16 v87, v61, v149, v87
  v_dot2_f32_bf16 v91, v61, v153, v91
  v_dot2_f32_bf16 v95, v61, v157, v95
  v_dot2_f32_bf16 v67, v62, v130, v67
  v_dot2_f32_bf16 v71, v62, v134, v71
  v_dot2_f32_bf16 v75, v62, v138, v75
  v_dot2_f32_bf16 v79, v62, v142, v79
  v_dot2_f32_bf16 v83, v62, v146, v83
  v_dot2_f32_bf16 v87, v62, v150, v87
  v_dot2_f32_bf16 v91, v62, v154, v91
  v_dot2_f32_bf16 v95, v62, v158, v95
  v_dot2_f32_bf16 v67, v63, v131, v67
  v_dot2_f32_bf16 v71, v63, v135, v71
  v_dot2_f32_bf16 v75, v63, v139, v75
  v_dot2_f32_bf16 v79, v63, v143, v79
  v_dot2_f32_bf16 v83, v63, v147, v83
  v_dot2_f32_bf16 v87, v63, v151, v87
  v_dot2_f32_bf16 v91, v63, v155, v91
  v_dot2_f32_bf16 v95, v63, v159, v95
  v_add_f32_dpp v96, v64, v64 row_ror:8 row_mask:0xf bank_mask:0x3
  v_add_f32_dpp v98, v68, v68 row_ror:8 row_mask:0xf bank_mask:0x3
  v_add_f32_dpp v100, v72, v72 row_ror:8 row_mask:0xf bank_mask:0x3
  v_add_f32_dpp v102, v76, v76 row_ror:8 row_mask:0xf bank_mask:0x3
  v_add_f32_dpp v104, v80, v80 row_ror:8 row_mask:0xf bank_mask:0x3
  v_add_f32_dpp v106, v84, v84 row_ror:8 row_mask:0xf bank_mask:0x3
  v_add_f32_dpp v108, v88, v88 row_ror:8 row_mask:0xf bank_mask:0x3
  v_add_f32_dpp v110, v92, v92 row_ror:8 row_mask:0xf bank_mask:0x3
  v_add_f32_dpp v97, v66, v66 row_ror:8 row_mask:0xf bank_mask:0x3
  v_add_f32_dpp v99, v70, v70 row_ror:8 row_mask:0xf bank_mask:0x3
  v_add_f32_dpp v101, v74, v74 row_ror:8 row_mask:0xf bank_mask:0x3
  v_add_f32_dpp v103, v78, v78 row_ror:8 row_mask:0xf bank_mask:0x3
  v_add_f32_dpp v105, v82, v82 row_ror:8 row_mask:0xf bank_mask:0x3
  v_add_f32_dpp v107, v86, v86 row_ror:8 row_mask:0xf bank_mask:0x3
  v_add_f32_dpp v109, v90, v90 row_ror:8 row_mask:0xf bank_mask:0x3
  v_add_f32_dpp v111, v94, v94 row_ror:8 row_mask:0xf bank_mask:0x3
  v_add_f32_dpp v96, v65, v65 row_ror:8 row_mask:0xf bank_mask:0xc
  v_add_f32_dpp v98, v69, v69 row_ror:8 row_mask:0xf bank_mask:0xc
  v_add_f32_dpp v100, v73, v73 row_ror:8 row_mask:0xf bank_mask:0xc
  v_add_f32_dpp v102, v77, v77 row_ror:8 row_mask:0xf bank_mask:0xc
  v_add_f32_dpp v104, v81, v81 row_ror:8 row_mask:0xf bank_mask:0xc
  v_add_f32_dpp v106, v85, v85 row_ror:8 row_mask:0xf bank_mask:0xc
  v_add_f32_dpp v108, v89, v89 row_ror:8 row_mask:0xf bank_mask:0xc
  v_add_f32_dpp v110, v93, v93 row_ror:8 row_mask:0xf bank_mask:0xc
  v_add_f32_dpp v97, v67, v67 row_ror:8 row_mask:0xf bank_mask:0xc
  v_add_f32_dpp v99, v71, v71 row_ror:8 row_mask:0xf bank_mask:0xc
  v_add_f32_dpp v101, v75, v75 row_ror:8 row_mask:0xf bank_mask:0xc
  v_add_f32_dpp v103, v79, v79 row_ror:8 row_mask:0xf bank_mask:0xc
  v_add_f32_dpp v105, v83, v83 row_ror:8 row_mask:0xf bank_mask:0xc
  v_add_f32_dpp v107, v87, v87 row_ror:8 row_mask:0xf bank_mask:0xc
  v_add_f32_dpp v109, v91, v91 row_ror:8 row_mask:0xf bank_mask:0xc
  v_add_f32_dpp v111, v95, v95 row_ror:8 row_mask:0xf bank_mask:0xc
  v_add_f32_dpp v120, v96, v96 row_half_mirror row_mask:0xf bank_mask:0x5
  v_add_f32_dpp v121, v98, v98 row_half_mirror row_mask:0xf bank_mask:0x5
  v_add_f32_dpp v122, v100, v100 row_half_mirror row_mask:0xf bank_mask:0x5
  v_add_f32_dpp v123, v102, v102 row_half_mirror row_mask:0xf bank_mask:0x5
  v_add_f32_dpp v124, v104, v104 row_half_mirror row_mask:0xf bank_mask:0x5
  v_add_f32_dpp v125, v106, v106 row_half_mirror row_mask:0xf bank_mask:0x5
  v_add_f32_dpp v126, v108, v108 row_half_mirror row_mask:0xf bank_mask:0x5
  v_add_f32_dpp v127, v110, v110 row_half_mirror row_mask:0xf bank_mask:0x5
  v_add_f32_dpp v120, v97, v97 row_half_mirror row_mask:0xf bank_mask:0xa
  v_add_f32_dpp v121, v99, v99 row_half_mirror row_mask:0xf bank_mask:0xa
  v_add_f32_dpp v122, v101, v101 row_half_mirror row_mask:0xf bank_mask:0xa
  v_add_f32_dpp v123, v103, v103 row_half_mirror row_mask:0xf bank_mask:0xa
  v_add_f32_dpp v124, v105, v105 row_half_mirror row_mask:0xf bank_mask:0xa
  v_add_f32_dpp v125, v107, v107 row_half_mirror row_mask:0xf bank_mask:0xa
  v_add_f32_dpp v126, v109, v109 row_half_mirror row_mask:0xf bank_mask:0xa
  v_add_f32_dpp v127, v111, v111 row_half_mirror row_mask:0xf bank_mask:0xa
  v_add_f32_dpp v120, v120, v120 quad_perm:[1,0,3,2] row_mask:0xf bank_mask:0xf
  v_add_f32_dpp v121, v121, v121 quad_perm:[1,0,3,2] row_mask:0xf bank_mask:0xf
  v_add_f32_dpp v122, v122, v122 quad_perm:[1,0,3,2] row_mask:0xf bank_mask:0xf
  v_add_f32_dpp v123, v123, v123 quad_perm:[1,0,3,2] row_mask:0xf bank_mask:0xf
  v_add_f32_dpp v124, v124, v124 quad_perm:[1,0,3,2] row_mask:0xf bank_mask:0xf
  v_add_f32_dpp v125, v125, v125 quad_perm:[1,0,3,2] row_mask:0xf bank_mask:0xf
  v_add_f32_dpp v126, v126, v126 quad_perm:[1,0,3,2] row_mask:0xf bank_mask:0xf
  v_add_f32_dpp v127, v127, v127 quad_perm:[1,0,3,2] row_mask:0xf bank_mask:0xf
  v_add_f32_dpp v120, v120, v120 quad_perm:[2,3,0,1] row_mask:0xf bank_mask:0xf
  v_add_f32_dpp v121, v121, v121 quad_perm:[2,3,0,1] row_mask:0xf bank_mask:0xf
  v_add_f32_dpp v122, v122, v122 quad_perm:[2,3,0,1] row_mask:0xf bank_mask:0xf
  v_add_f32_dpp v123, v123, v123 quad_perm:[2,3,0,1] row_mask:0xf bank_mask:0xf
  v_add_f32_dpp v124, v124, v124 quad_perm:[2,3,0,1] row_mask:0xf bank_mask:0xf
  v_add_f32_dpp v125, v125, v125 quad_perm:[2,3,0,1] row_mask:0xf bank_mask:0xf
  v_add_f32_dpp v126, v126, v126 quad_perm:[2,3,0,1] row_mask:0xf bank_mask:0xf
  v_add_f32_dpp v127, v127, v127 quad_perm:[2,3,0,1] row_mask:0xf bank_mask:0xf
  v_max_f32 v112, v112, v120
  ds_write_b32 v248, v120 offset:4100
  v_max_f32 v113, v113, v121
  ds_write_b32 v248, v121 offset:4228
  v_max_f32 v114, v114, v122
  ds_write_b32 v248, v122 offset:4356
  v_max_f32 v115, v115, v123
  ds_write_b32 v248, v123 offset:4484
  v_max_f32 v116, v116, v124
  ds_write_b32 v248, v124 offset:4612
  v_max_f32 v117, v117, v125
  ds_write_b32 v248, v125 offset:4740
  v_max_f32 v118, v118, v126
  ds_write_b32 v248, v126 offset:4868
  v_max_f32 v119, v119, v127
  ds_write_b32 v248, v127 offset:4996
  s_mov_b32 s87, s25
  v_add_u32 v248, 1024, v248
  s_cbranch_scc0 L_ak
  v_max_f32_dpp v112, v112, v112 row_ror:4 row_mask:0xf bank_mask:0xf
  v_max_f32_dpp v113, v113, v113 row_ror:4 row_mask:0xf bank_mask:0xf
  v_max_f32_dpp v114, v114, v114 row_ror:4 row_mask:0xf bank_mask:0xf
  v_max_f32_dpp v115, v115, v115 row_ror:4 row_mask:0xf bank_mask:0xf
  v_max_f32_dpp v116, v116, v116 row_ror:4 row_mask:0xf bank_mask:0xf
  v_max_f32_dpp v117, v117, v117 row_ror:4 row_mask:0xf bank_mask:0xf
  v_max_f32_dpp v118, v118, v118 row_ror:4 row_mask:0xf bank_mask:0xf
  v_max_f32_dpp v119, v119, v119 row_ror:4 row_mask:0xf bank_mask:0xf
  v_max_f32_dpp v112, v112, v112 row_ror:8 row_mask:0xf bank_mask:0xf
  v_max_f32_dpp v113, v113, v113 row_ror:8 row_mask:0xf bank_mask:0xf
  v_max_f32_dpp v114, v114, v114 row_ror:8 row_mask:0xf bank_mask:0xf
  v_max_f32_dpp v115, v115, v115 row_ror:8 row_mask:0xf bank_mask:0xf
  v_max_f32_dpp v116, v116, v116 row_ror:8 row_mask:0xf bank_mask:0xf
  v_max_f32_dpp v117, v117, v117 row_ror:8 row_mask:0xf bank_mask:0xf
  v_max_f32_dpp v118, v118, v118 row_ror:8 row_mask:0xf bank_mask:0xf
  v_max_f32_dpp v119, v119, v119 row_ror:8 row_mask:0xf bank_mask:0xf
  v_mul_f32 v224, s92, v112
  v_mul_f32 v225, s92, v113
  v_mul_f32 v226, s92, v114
  v_mul_f32 v227, s92, v115
  v_mul_f32 v228, s92, v116
  v_mul_f32 v229, s92, v117
  v_mul_f32 v230, s92, v118
  v_mul_f32 v231, s92, v119
  v_mov_b32 v160, 0
  v_mov_b32 v161, 0
  v_mov_b32 v162, 0
  v_mov_b32 v163, 0
  v_mov_b32 v164, 0
  v_mov_b32 v165, 0
  v_mov_b32 v166, 0
  v_mov_b32 v167, 0
  v_mov_b32 v168, 0
  v_mov_b32 v169, 0
  v_mov_b32 v170, 0
  v_mov_b32 v171, 0
  v_mov_b32 v172, 0
  v_mov_b32 v173, 0
  v_mov_b32 v174, 0
  v_mov_b32 v175, 0
  v_mov_b32 v176, 0
  v_mov_b32 v177, 0
  v_mov_b32 v178, 0
  v_mov_b32 v179, 0
  v_mov_b32 v180, 0
  v_mov_b32 v181, 0
  v_mov_b32 v182, 0
  v_mov_b32 v183, 0
  v_mov_b32 v184, 0
  v_mov_b32 v185, 0
  v_mov_b32 v186, 0
  v_mov_b32 v187, 0
  v_mov_b32 v188, 0
  v_mov_b32 v189, 0
  v_mov_b32 v190, 0
  v_mov_b32 v191, 0
  v_mov_b32 v192, 0
  v_mov_b32 v193, 0
  v_mov_b32 v194, 0
  v_mov_b32 v195, 0
  v_mov_b32 v196, 0
  v_mov_b32 v197, 0
  v_mov_b32 v198, 0
  v_mov_b32 v199, 0
  v_mov_b32 v200, 0
  v_mov_b32 v201, 0
  v_mov_b32 v202, 0
  v_mov_b32 v203, 0
  v_mov_b32 v204, 0
  v_mov_b32 v205, 0
  v_mov_b32 v206, 0
  v_mov_b32 v207, 0
  v_mov_b32 v208, 0
  v_mov_b32 v209, 0
  v_mov_b32 v210, 0
  v_mov_b32 v211, 0
  v_mov_b32 v212, 0
  v_mov_b32 v213, 0
  v_mov_b32 v214, 0
  v_mov_b32 v215, 0
  v_mov_b32 v216, 0
  v_mov_b32 v217, 0
  v_mov_b32 v218, 0
  v_mov_b32 v219, 0
  v_mov_b32 v220, 0
  v_mov_b32 v221, 0
  v_mov_b32 v222, 0
  v_mov_b32 v223, 0
  v_mov_b32 v248, v251
  v_readlane_b32 s30, v243, 0
  s_mov_b32 s31, 4
L_av:
  ds_read_b64 v[64:65], v248 offset:4096
  ds_read_b64 v[66:67], v248 offset:4224
  ds_read_b64 v[68:69], v248 offset:4352
  ds_read_b64 v[70:71], v248 offset:4480
  ds_read_b64 v[72:73], v248 offset:4608
  ds_read_b64 v[74:75], v248 offset:4736
  ds_read_b64 v[76:77], v248 offset:4864
  ds_read_b64 v[78:79], v248 offset:4992
  s_sub_u32 s31, s31, 1
  s_add_u32 s25, s87, 32768
  s_cmp_eq_u32 s31, 0
  s_cselect_b32 s12, s36, s60
  s_cselect_b32 s13, s37, s61
  s_cselect_b32 s14, s38, s62
  s_cselect_b32 s23, 1, 0
  s_add_u32 s16, s25, 0
  s_xor_b32 s93, s30, 0x0
  s_cmp_eq_u32 s23, 0
  s_cselect_b32 s16, s16, s93
  s_add_u32 s17, s25, 1024
  s_xor_b32 s93, s30, 0x300
  s_cmp_eq_u32 s23, 0
  s_cselect_b32 s17, s17, s93
  s_add_u32 s18, s25, 2048
  s_xor_b32 s93, s30, 0x40000
  s_cmp_eq_u32 s23, 0
  s_cselect_b32 s18, s18, s93
  s_add_u32 s19, s25, 3072
  s_xor_b32 s93, s30, 0x40300
  s_cmp_eq_u32 s23, 0
  s_cselect_b32 s19, s19, s93
  s_add_u32 s20, s25, 4096
  s_xor_b32 s93, s30, 0x200400
  s_cmp_eq_u32 s23, 0
  s_cselect_b32 s20, s20, s93
  s_mov_b32 s25, s16
  s_cselect_b64 vcc, -1, 0
  v_cndmask_b32 v30, v253, v1, vcc
  s_waitcnt vmcnt(4)
  buffer_load_dwordx4 v[52:55], v31, s[60:63], s87 offen offset:1024 nt
  buffer_load_dwordx4 v[56:59], v31, s[60:63], s87 offen offset:2048 nt
  s_waitcnt lgkmcnt(0)
  v_fma_f32 v64, v64, s92, -v224
  v_fma_f32 v65, v65, s92, -v224
  v_fma_f32 v66, v66, s92, -v225
  v_fma_f32 v67, v67, s92, -v225
  v_fma_f32 v68, v68, s92, -v226
  v_fma_f32 v69, v69, s92, -v226
  v_fma_f32 v70, v70, s92, -v227
  v_fma_f32 v71, v71, s92, -v227
  v_fma_f32 v72, v72, s92, -v228
  v_fma_f32 v73, v73, s92, -v228
  v_fma_f32 v74, v74, s92, -v229
  v_fma_f32 v75, v75, s92, -v229
  v_fma_f32 v76, v76, s92, -v230
  v_fma_f32 v77, v77, s92, -v230
  v_fma_f32 v78, v78, s92, -v231
  v_fma_f32 v79, v79, s92, -v231
  v_exp_f32 v64, v64
  v_exp_f32 v65, v65
  v_exp_f32 v66, v66
  v_exp_f32 v67, v67
  v_exp_f32 v68, v68
  v_exp_f32 v69, v69
  v_exp_f32 v70, v70
  v_exp_f32 v71, v71
  v_exp_f32 v72, v72
  v_exp_f32 v73, v73
  v_exp_f32 v74, v74
  v_exp_f32 v75, v75
  v_exp_f32 v76, v76
  v_exp_f32 v77, v77
  v_exp_f32 v78, v78
  v_exp_f32 v79, v79
  v_cvt_pk_bf16_f32 v80, v64, 0
  v_add_f32 v232, v232, v64
  v_cvt_pk_bf16_f32 v82, v65, 0
  v_add_f32 v232, v232, v65
  v_cvt_pk_bf16_f32 v84, v66, 0
  v_add_f32 v233, v233, v66
  v_cvt_pk_bf16_f32 v86, v67, 0
  v_add_f32 v233, v233, v67
  v_cvt_pk_bf16_f32 v88, v68, 0
  v_add_f32 v234, v234, v68
  v_cvt_pk_bf16_f32 v90, v69, 0
  v_add_f32 v234, v234, v69
  v_cvt_pk_bf16_f32 v92, v70, 0
  v_add_f32 v235, v235, v70
  v_cvt_pk_bf16_f32 v94, v71, 0
  v_add_f32 v235, v235, v71
  v_cvt_pk_bf16_f32 v96, v72, 0
  v_add_f32 v236, v236, v72
  v_cvt_pk_bf16_f32 v98, v73, 0
  v_add_f32 v236, v236, v73
  v_cvt_pk_bf16_f32 v100, v74, 0
  v_add_f32 v237, v237, v74
  v_cvt_pk_bf16_f32 v102, v75, 0
  v_add_f32 v237, v237, v75
  v_cvt_pk_bf16_f32 v104, v76, 0
  v_add_f32 v238, v238, v76
  v_cvt_pk_bf16_f32 v106, v77, 0
  v_add_f32 v238, v238, v77
  v_cvt_pk_bf16_f32 v108, v78, 0
  v_add_f32 v239, v239, v78
  v_cvt_pk_bf16_f32 v110, v79, 0
  v_add_f32 v239, v239, v79
  v_lshlrev_b32 v81, 16, v80
  v_lshlrev_b32 v83, 16, v82
  v_lshlrev_b32 v85, 16, v84
  v_lshlrev_b32 v87, 16, v86
  v_lshlrev_b32 v89, 16, v88
  v_lshlrev_b32 v91, 16, v90
  v_lshlrev_b32 v93, 16, v92
  v_lshlrev_b32 v95, 16, v94
  v_lshlrev_b32 v97, 16, v96
  v_lshlrev_b32 v99, 16, v98
  v_lshlrev_b32 v101, 16, v100
  v_lshlrev_b32 v103, 16, v102
  v_lshlrev_b32 v105, 16, v104
  v_lshlrev_b32 v107, 16, v106
  v_lshlrev_b32 v109, 16, v108
  v_lshlrev_b32 v111, 16, v110
  v_dot2c_f32_bf16_dpp v160, v80, v32 row_newbcast:0 row_mask:0xf bank_mask:0xf
  v_dot2c_f32_bf16_dpp v161, v81, v32 row_newbcast:0 row_mask:0xf bank_mask:0xf
  v_dot2c_f32_bf16_dpp v162, v80, v33 row_newbcast:0 row_mask:0xf bank_mask:0xf
  v_dot2c_f32_bf16_dpp v163, v81, v33 row_newbcast:0 row_mask:0xf bank_mask:0xf
  v_dot2c_f32_bf16_dpp v164, v80, v34 row_newbcast:0 row_mask:0xf bank_mask:0xf
  v_dot2c_f32_bf16_dpp v165, v81, v34 row_newbcast:0 row_mask:0xf bank_mask:0xf
  v_dot2c_f32_bf16_dpp v166, v80, v35 row_newbcast:0 row_mask:0xf bank_mask:0xf
  v_dot2c_f32_bf16_dpp v167, v81, v35 row_newbcast:0 row_mask:0xf bank_mask:0xf
  v_dot2c_f32_bf16_dpp v168, v84, v32 row_newbcast:0 row_mask:0xf bank_mask:0xf
  v_dot2c_f32_bf16_dpp v169, v85, v32 row_newbcast:0 row_mask:0xf bank_mask:0xf
  v_dot2c_f32_bf16_dpp v170, v84, v33 row_newbcast:0 row_mask:0xf bank_mask:0xf
  v_dot2c_f32_bf16_dpp v171, v85, v33 row_newbcast:0 row_mask:0xf bank_mask:0xf
  v_dot2c_f32_bf16_dpp v172, v84, v34 row_newbcast:0 row_mask:0xf bank_mask:0xf
  v_dot2c_f32_bf16_dpp v173, v85, v34 row_newbcast:0 row_mask:0xf bank_mask:0xf
  v_dot2c_f32_bf16_dpp v174, v84, v35 row_newbcast:0 row_mask:0xf bank_mask:0xf
  v_dot2c_f32_bf16_dpp v175, v85, v35 row_newbcast:0 row_mask:0xf bank_mask:0xf
  v_dot2c_f32_bf16_dpp v176, v88, v32 row_newbcast:0 row_mask:0xf bank_mask:0xf
  v_dot2c_f32_bf16_dpp v177, v89, v32 row_newbcast:0 row_mask:0xf bank_mask:0xf
  v_dot2c_f32_bf16_dpp v178, v88, v33 row_newbcast:0 row_mask:0xf bank_mask:0xf
  v_dot2c_f32_bf16_dpp v179, v89, v33 row_newbcast:0 row_mask:0xf bank_mask:0xf
  v_dot2c_f32_bf16_dpp v180, v88, v34 row_newbcast:0 row_mask:0xf bank_mask:0xf
  v_dot2c_f32_bf16_dpp v181, v89, v34 row_newbcast:0 row_mask:0xf bank_mask:0xf
  v_dot2c_f32_bf16_dpp v182, v88, v35 row_newbcast:0 row_mask:0xf bank_mask:0xf
  v_dot2c_f32_bf16_dpp v183, v89, v35 row_newbcast:0 row_mask:0xf bank_mask:0xf
  v_dot2c_f32_bf16_dpp v184, v92, v32 row_newbcast:0 row_mask:0xf bank_mask:0xf
  v_dot2c_f32_bf16_dpp v185, v93, v32 row_newbcast:0 row_mask:0xf bank_mask:0xf
  v_dot2c_f32_bf16_dpp v186, v92, v33 row_newbcast:0 row_mask:0xf bank_mask:0xf
  v_dot2c_f32_bf16_dpp v187, v93, v33 row_newbcast:0 row_mask:0xf bank_mask:0xf
  v_dot2c_f32_bf16_dpp v188, v92, v34 row_newbcast:0 row_mask:0xf bank_mask:0xf
  v_dot2c_f32_bf16_dpp v189, v93, v34 row_newbcast:0 row_mask:0xf bank_mask:0xf
  v_dot2c_f32_bf16_dpp v190, v92, v35 row_newbcast:0 row_mask:0xf bank_mask:0xf
  v_dot2c_f32_bf16_dpp v191, v93, v35 row_newbcast:0 row_mask:0xf bank_mask:0xf
  v_dot2c_f32_bf16_dpp v192, v96, v32 row_newbcast:0 row_mask:0xf bank_mask:0xf
  v_dot2c_f32_bf16_dpp v193, v97, v32 row_newbcast:0 row_mask:0xf bank_mask:0xf
  v_dot2c_f32_bf16_dpp v194, v96, v33 row_newbcast:0 row_mask:0xf bank_mask:0xf
  v_dot2c_f32_bf16_dpp v195, v97, v33 row_newbcast:0 row_mask:0xf bank_mask:0xf
  v_dot2c_f32_bf16_dpp v196, v96, v34 row_newbcast:0 row_mask:0xf bank_mask:0xf
  v_dot2c_f32_bf16_dpp v197, v97, v34 row_newbcast:0 row_mask:0xf bank_mask:0xf
  v_dot2c_f32_bf16_dpp v198, v96, v35 row_newbcast:0 row_mask:0xf bank_mask:0xf
  v_dot2c_f32_bf16_dpp v199, v97, v35 row_newbcast:0 row_mask:0xf bank_mask:0xf
  v_dot2c_f32_bf16_dpp v200, v100, v32 row_newbcast:0 row_mask:0xf bank_mask:0xf
  v_dot2c_f32_bf16_dpp v201, v101, v32 row_newbcast:0 row_mask:0xf bank_mask:0xf
  v_dot2c_f32_bf16_dpp v202, v100, v33 row_newbcast:0 row_mask:0xf bank_mask:0xf
  v_dot2c_f32_bf16_dpp v203, v101, v33 row_newbcast:0 row_mask:0xf bank_mask:0xf
  v_dot2c_f32_bf16_dpp v204, v100, v34 row_newbcast:0 row_mask:0xf bank_mask:0xf
  v_dot2c_f32_bf16_dpp v205, v101, v34 row_newbcast:0 row_mask:0xf bank_mask:0xf
  v_dot2c_f32_bf16_dpp v206, v100, v35 row_newbcast:0 row_mask:0xf bank_mask:0xf
  v_dot2c_f32_bf16_dpp v207, v101, v35 row_newbcast:0 row_mask:0xf bank_mask:0xf
  v_dot2c_f32_bf16_dpp v208, v104, v32 row_newbcast:0 row_mask:0xf bank_mask:0xf
  v_dot2c_f32_bf16_dpp v209, v105, v32 row_newbcast:0 row_mask:0xf bank_mask:0xf
  v_dot2c_f32_bf16_dpp v210, v104, v33 row_newbcast:0 row_mask:0xf bank_mask:0xf
  v_dot2c_f32_bf16_dpp v211, v105, v33 row_newbcast:0 row_mask:0xf bank_mask:0xf
  v_dot2c_f32_bf16_dpp v212, v104, v34 row_newbcast:0 row_mask:0xf bank_mask:0xf
  v_dot2c_f32_bf16_dpp v213, v105, v34 row_newbcast:0 row_mask:0xf bank_mask:0xf
  v_dot2c_f32_bf16_dpp v214, v104, v35 row_newbcast:0 row_mask:0xf bank_mask:0xf
  v_dot2c_f32_bf16_dpp v215, v105, v35 row_newbcast:0 row_mask:0xf bank_mask:0xf
  v_dot2c_f32_bf16_dpp v216, v108, v32 row_newbcast:0 row_mask:0xf bank_mask:0xf
  v_dot2c_f32_bf16_dpp v217, v109, v32 row_newbcast:0 row_mask:0xf bank_mask:0xf
  v_dot2c_f32_bf16_dpp v218, v108, v33 row_newbcast:0 row_mask:0xf bank_mask:0xf
  v_dot2c_f32_bf16_dpp v219, v109, v33 row_newbcast:0 row_mask:0xf bank_mask:0xf
  v_dot2c_f32_bf16_dpp v220, v108, v34 row_newbcast:0 row_mask:0xf bank_mask:0xf
  v_dot2c_f32_bf16_dpp v221, v109, v34 row_newbcast:0 row_mask:0xf bank_mask:0xf
  v_dot2c_f32_bf16_dpp v222, v108, v35 row_newbcast:0 row_mask:0xf bank_mask:0xf
  v_dot2c_f32_bf16_dpp v223, v109, v35 row_newbcast:0 row_mask:0xf bank_mask:0xf
  s_waitcnt vmcnt(5)
  buffer_load_dwordx4 v[60:63], v31, s[60:63], s87 offen offset:3072 nt
  v_xor_b32 v25, s16, v30
  buffer_load_dwordx4 v[32:35], v25, s[12:15], 0 offen offset:0 nt
  v_dot2c_f32_bf16_dpp v160, v80, v36 row_newbcast:8 row_mask:0xf bank_mask:0xf
  v_dot2c_f32_bf16_dpp v161, v81, v36 row_newbcast:8 row_mask:0xf bank_mask:0xf
  v_dot2c_f32_bf16_dpp v162, v80, v37 row_newbcast:8 row_mask:0xf bank_mask:0xf
  v_dot2c_f32_bf16_dpp v163, v81, v37 row_newbcast:8 row_mask:0xf bank_mask:0xf
  v_dot2c_f32_bf16_dpp v164, v80, v38 row_newbcast:8 row_mask:0xf bank_mask:0xf
  v_dot2c_f32_bf16_dpp v165, v81, v38 row_newbcast:8 row_mask:0xf bank_mask:0xf
  v_dot2c_f32_bf16_dpp v166, v80, v39 row_newbcast:8 row_mask:0xf bank_mask:0xf
  v_dot2c_f32_bf16_dpp v167, v81, v39 row_newbcast:8 row_mask:0xf bank_mask:0xf
  v_dot2c_f32_bf16_dpp v168, v84, v36 row_newbcast:8 row_mask:0xf bank_mask:0xf
  v_dot2c_f32_bf16_dpp v169, v85, v36 row_newbcast:8 row_mask:0xf bank_mask:0xf
  v_dot2c_f32_bf16_dpp v170, v84, v37 row_newbcast:8 row_mask:0xf bank_mask:0xf
  v_dot2c_f32_bf16_dpp v171, v85, v37 row_newbcast:8 row_mask:0xf bank_mask:0xf
  v_dot2c_f32_bf16_dpp v172, v84, v38 row_newbcast:8 row_mask:0xf bank_mask:0xf
  v_dot2c_f32_bf16_dpp v173, v85, v38 row_newbcast:8 row_mask:0xf bank_mask:0xf
  v_dot2c_f32_bf16_dpp v174, v84, v39 row_newbcast:8 row_mask:0xf bank_mask:0xf
  v_dot2c_f32_bf16_dpp v175, v85, v39 row_newbcast:8 row_mask:0xf bank_mask:0xf
  v_dot2c_f32_bf16_dpp v176, v88, v36 row_newbcast:8 row_mask:0xf bank_mask:0xf
  v_dot2c_f32_bf16_dpp v177, v89, v36 row_newbcast:8 row_mask:0xf bank_mask:0xf
  v_dot2c_f32_bf16_dpp v178, v88, v37 row_newbcast:8 row_mask:0xf bank_mask:0xf
  v_dot2c_f32_bf16_dpp v179, v89, v37 row_newbcast:8 row_mask:0xf bank_mask:0xf
  v_dot2c_f32_bf16_dpp v180, v88, v38 row_newbcast:8 row_mask:0xf bank_mask:0xf
  v_dot2c_f32_bf16_dpp v181, v89, v38 row_newbcast:8 row_mask:0xf bank_mask:0xf
  v_dot2c_f32_bf16_dpp v182, v88, v39 row_newbcast:8 row_mask:0xf bank_mask:0xf
  v_dot2c_f32_bf16_dpp v183, v89, v39 row_newbcast:8 row_mask:0xf bank_mask:0xf
  v_dot2c_f32_bf16_dpp v184, v92, v36 row_newbcast:8 row_mask:0xf bank_mask:0xf
  v_dot2c_f32_bf16_dpp v185, v93, v36 row_newbcast:8 row_mask:0xf bank_mask:0xf
  v_dot2c_f32_bf16_dpp v186, v92, v37 row_newbcast:8 row_mask:0xf bank_mask:0xf
  v_dot2c_f32_bf16_dpp v187, v93, v37 row_newbcast:8 row_mask:0xf bank_mask:0xf
  v_dot2c_f32_bf16_dpp v188, v92, v38 row_newbcast:8 row_mask:0xf bank_mask:0xf
  v_dot2c_f32_bf16_dpp v189, v93, v38 row_newbcast:8 row_mask:0xf bank_mask:0xf
  v_dot2c_f32_bf16_dpp v190, v92, v39 row_newbcast:8 row_mask:0xf bank_mask:0xf
  v_dot2c_f32_bf16_dpp v191, v93, v39 row_newbcast:8 row_mask:0xf bank_mask:0xf
  v_dot2c_f32_bf16_dpp v192, v96, v36 row_newbcast:8 row_mask:0xf bank_mask:0xf
  v_dot2c_f32_bf16_dpp v193, v97, v36 row_newbcast:8 row_mask:0xf bank_mask:0xf
  v_dot2c_f32_bf16_dpp v194, v96, v37 row_newbcast:8 row_mask:0xf bank_mask:0xf
  v_dot2c_f32_bf16_dpp v195, v97, v37 row_newbcast:8 row_mask:0xf bank_mask:0xf
  v_dot2c_f32_bf16_dpp v196, v96, v38 row_newbcast:8 row_mask:0xf bank_mask:0xf
  v_dot2c_f32_bf16_dpp v197, v97, v38 row_newbcast:8 row_mask:0xf bank_mask:0xf
  v_dot2c_f32_bf16_dpp v198, v96, v39 row_newbcast:8 row_mask:0xf bank_mask:0xf
  v_dot2c_f32_bf16_dpp v199, v97, v39 row_newbcast:8 row_mask:0xf bank_mask:0xf
  v_dot2c_f32_bf16_dpp v200, v100, v36 row_newbcast:8 row_mask:0xf bank_mask:0xf
  v_dot2c_f32_bf16_dpp v201, v101, v36 row_newbcast:8 row_mask:0xf bank_mask:0xf
  v_dot2c_f32_bf16_dpp v202, v100, v37 row_newbcast:8 row_mask:0xf bank_mask:0xf
  v_dot2c_f32_bf16_dpp v203, v101, v37 row_newbcast:8 row_mask:0xf bank_mask:0xf
  v_dot2c_f32_bf16_dpp v204, v100, v38 row_newbcast:8 row_mask:0xf bank_mask:0xf
  v_dot2c_f32_bf16_dpp v205, v101, v38 row_newbcast:8 row_mask:0xf bank_mask:0xf
  v_dot2c_f32_bf16_dpp v206, v100, v39 row_newbcast:8 row_mask:0xf bank_mask:0xf
  v_dot2c_f32_bf16_dpp v207, v101, v39 row_newbcast:8 row_mask:0xf bank_mask:0xf
  v_dot2c_f32_bf16_dpp v208, v104, v36 row_newbcast:8 row_mask:0xf bank_mask:0xf
  v_dot2c_f32_bf16_dpp v209, v105, v36 row_newbcast:8 row_mask:0xf bank_mask:0xf
  v_dot2c_f32_bf16_dpp v210, v104, v37 row_newbcast:8 row_mask:0xf bank_mask:0xf
  v_dot2c_f32_bf16_dpp v211, v105, v37 row_newbcast:8 row_mask:0xf bank_mask:0xf
  v_dot2c_f32_bf16_dpp v212, v104, v38 row_newbcast:8 row_mask:0xf bank_mask:0xf
  v_dot2c_f32_bf16_dpp v213, v105, v38 row_newbcast:8 row_mask:0xf bank_mask:0xf
  v_dot2c_f32_bf16_dpp v214, v104, v39 row_newbcast:8 row_mask:0xf bank_mask:0xf
  v_dot2c_f32_bf16_dpp v215, v105, v39 row_newbcast:8 row_mask:0xf bank_mask:0xf
  v_dot2c_f32_bf16_dpp v216, v108, v36 row_newbcast:8 row_mask:0xf bank_mask:0xf
  v_dot2c_f32_bf16_dpp v217, v109, v36 row_newbcast:8 row_mask:0xf bank_mask:0xf
  v_dot2c_f32_bf16_dpp v218, v108, v37 row_newbcast:8 row_mask:0xf bank_mask:0xf
  v_dot2c_f32_bf16_dpp v219, v109, v37 row_newbcast:8 row_mask:0xf bank_mask:0xf
  v_dot2c_f32_bf16_dpp v220, v108, v38 row_newbcast:8 row_mask:0xf bank_mask:0xf
  v_dot2c_f32_bf16_dpp v221, v109, v38 row_newbcast:8 row_mask:0xf bank_mask:0xf
  v_dot2c_f32_bf16_dpp v222, v108, v39 row_newbcast:8 row_mask:0xf bank_mask:0xf
  v_dot2c_f32_bf16_dpp v223, v109, v39 row_newbcast:8 row_mask:0xf bank_mask:0xf
  s_waitcnt vmcnt(6)
  v_xor_b32 v27, s17, v30
  buffer_load_dwordx4 v[36:39], v27, s[12:15], 0 offen offset:0 nt
  v_dot2c_f32_bf16_dpp v160, v80, v40 row_newbcast:4 row_mask:0xf bank_mask:0xf
  v_dot2c_f32_bf16_dpp v161, v81, v40 row_newbcast:4 row_mask:0xf bank_mask:0xf
  v_dot2c_f32_bf16_dpp v162, v80, v41 row_newbcast:4 row_mask:0xf bank_mask:0xf
  v_dot2c_f32_bf16_dpp v163, v81, v41 row_newbcast:4 row_mask:0xf bank_mask:0xf
  v_dot2c_f32_bf16_dpp v164, v80, v42 row_newbcast:4 row_mask:0xf bank_mask:0xf
  v_dot2c_f32_bf16_dpp v165, v81, v42 row_newbcast:4 row_mask:0xf bank_mask:0xf
  v_dot2c_f32_bf16_dpp v166, v80, v43 row_newbcast:4 row_mask:0xf bank_mask:0xf
  v_dot2c_f32_bf16_dpp v167, v81, v43 row_newbcast:4 row_mask:0xf bank_mask:0xf
  v_dot2c_f32_bf16_dpp v168, v84, v40 row_newbcast:4 row_mask:0xf bank_mask:0xf
  v_dot2c_f32_bf16_dpp v169, v85, v40 row_newbcast:4 row_mask:0xf bank_mask:0xf
  v_dot2c_f32_bf16_dpp v170, v84, v41 row_newbcast:4 row_mask:0xf bank_mask:0xf
  v_dot2c_f32_bf16_dpp v171, v85, v41 row_newbcast:4 row_mask:0xf bank_mask:0xf
  v_dot2c_f32_bf16_dpp v172, v84, v42 row_newbcast:4 row_mask:0xf bank_mask:0xf
  v_dot2c_f32_bf16_dpp v173, v85, v42 row_newbcast:4 row_mask:0xf bank_mask:0xf
  v_dot2c_f32_bf16_dpp v174, v84, v43 row_newbcast:4 row_mask:0xf bank_mask:0xf
  v_dot2c_f32_bf16_dpp v175, v85, v43 row_newbcast:4 row_mask:0xf bank_mask:0xf
  v_dot2c_f32_bf16_dpp v176, v88, v40 row_newbcast:4 row_mask:0xf bank_mask:0xf
  v_dot2c_f32_bf16_dpp v177, v89, v40 row_newbcast:4 row_mask:0xf bank_mask:0xf
  v_dot2c_f32_bf16_dpp v178, v88, v41 row_newbcast:4 row_mask:0xf bank_mask:0xf
  v_dot2c_f32_bf16_dpp v179, v89, v41 row_newbcast:4 row_mask:0xf bank_mask:0xf
  v_dot2c_f32_bf16_dpp v180, v88, v42 row_newbcast:4 row_mask:0xf bank_mask:0xf
  v_dot2c_f32_bf16_dpp v181, v89, v42 row_newbcast:4 row_mask:0xf bank_mask:0xf
  v_dot2c_f32_bf16_dpp v182, v88, v43 row_newbcast:4 row_mask:0xf bank_mask:0xf
  v_dot2c_f32_bf16_dpp v183, v89, v43 row_newbcast:4 row_mask:0xf bank_mask:0xf
  v_dot2c_f32_bf16_dpp v184, v92, v40 row_newbcast:4 row_mask:0xf bank_mask:0xf
  v_dot2c_f32_bf16_dpp v185, v93, v40 row_newbcast:4 row_mask:0xf bank_mask:0xf
  v_dot2c_f32_bf16_dpp v186, v92, v41 row_newbcast:4 row_mask:0xf bank_mask:0xf
  v_dot2c_f32_bf16_dpp v187, v93, v41 row_newbcast:4 row_mask:0xf bank_mask:0xf
  v_dot2c_f32_bf16_dpp v188, v92, v42 row_newbcast:4 row_mask:0xf bank_mask:0xf
  v_dot2c_f32_bf16_dpp v189, v93, v42 row_newbcast:4 row_mask:0xf bank_mask:0xf
  v_dot2c_f32_bf16_dpp v190, v92, v43 row_newbcast:4 row_mask:0xf bank_mask:0xf
  v_dot2c_f32_bf16_dpp v191, v93, v43 row_newbcast:4 row_mask:0xf bank_mask:0xf
  v_dot2c_f32_bf16_dpp v192, v96, v40 row_newbcast:4 row_mask:0xf bank_mask:0xf
  v_dot2c_f32_bf16_dpp v193, v97, v40 row_newbcast:4 row_mask:0xf bank_mask:0xf
  v_dot2c_f32_bf16_dpp v194, v96, v41 row_newbcast:4 row_mask:0xf bank_mask:0xf
  v_dot2c_f32_bf16_dpp v195, v97, v41 row_newbcast:4 row_mask:0xf bank_mask:0xf
  v_dot2c_f32_bf16_dpp v196, v96, v42 row_newbcast:4 row_mask:0xf bank_mask:0xf
  v_dot2c_f32_bf16_dpp v197, v97, v42 row_newbcast:4 row_mask:0xf bank_mask:0xf
  v_dot2c_f32_bf16_dpp v198, v96, v43 row_newbcast:4 row_mask:0xf bank_mask:0xf
  v_dot2c_f32_bf16_dpp v199, v97, v43 row_newbcast:4 row_mask:0xf bank_mask:0xf
  v_dot2c_f32_bf16_dpp v200, v100, v40 row_newbcast:4 row_mask:0xf bank_mask:0xf
  v_dot2c_f32_bf16_dpp v201, v101, v40 row_newbcast:4 row_mask:0xf bank_mask:0xf
  v_dot2c_f32_bf16_dpp v202, v100, v41 row_newbcast:4 row_mask:0xf bank_mask:0xf
  v_dot2c_f32_bf16_dpp v203, v101, v41 row_newbcast:4 row_mask:0xf bank_mask:0xf
  v_dot2c_f32_bf16_dpp v204, v100, v42 row_newbcast:4 row_mask:0xf bank_mask:0xf
  v_dot2c_f32_bf16_dpp v205, v101, v42 row_newbcast:4 row_mask:0xf bank_mask:0xf
  v_dot2c_f32_bf16_dpp v206, v100, v43 row_newbcast:4 row_mask:0xf bank_mask:0xf
  v_dot2c_f32_bf16_dpp v207, v101, v43 row_newbcast:4 row_mask:0xf bank_mask:0xf
  v_dot2c_f32_bf16_dpp v208, v104, v40 row_newbcast:4 row_mask:0xf bank_mask:0xf
  v_dot2c_f32_bf16_dpp v209, v105, v40 row_newbcast:4 row_mask:0xf bank_mask:0xf
  v_dot2c_f32_bf16_dpp v210, v104, v41 row_newbcast:4 row_mask:0xf bank_mask:0xf
  v_dot2c_f32_bf16_dpp v211, v105, v41 row_newbcast:4 row_mask:0xf bank_mask:0xf
  v_dot2c_f32_bf16_dpp v212, v104, v42 row_newbcast:4 row_mask:0xf bank_mask:0xf
  v_dot2c_f32_bf16_dpp v213, v105, v42 row_newbcast:4 row_mask:0xf bank_mask:0xf
  v_dot2c_f32_bf16_dpp v214, v104, v43 row_newbcast:4 row_mask:0xf bank_mask:0xf
  v_dot2c_f32_bf16_dpp v215, v105, v43 row_newbcast:4 row_mask:0xf bank_mask:0xf
  v_dot2c_f32_bf16_dpp v216, v108, v40 row_newbcast:4 row_mask:0xf bank_mask:0xf
  v_dot2c_f32_bf16_dpp v217, v109, v40 row_newbcast:4 row_mask:0xf bank_mask:0xf
  v_dot2c_f32_bf16_dpp v218, v108, v41 row_newbcast:4 row_mask:0xf bank_mask:0xf
  v_dot2c_f32_bf16_dpp v219, v109, v41 row_newbcast:4 row_mask:0xf bank_mask:0xf
  v_dot2c_f32_bf16_dpp v220, v108, v42 row_newbcast:4 row_mask:0xf bank_mask:0xf
  v_dot2c_f32_bf16_dpp v221, v109, v42 row_newbcast:4 row_mask:0xf bank_mask:0xf
  v_dot2c_f32_bf16_dpp v222, v108, v43 row_newbcast:4 row_mask:0xf bank_mask:0xf
  v_dot2c_f32_bf16_dpp v223, v109, v43 row_newbcast:4 row_mask:0xf bank_mask:0xf
  s_waitcnt vmcnt(6)
  v_xor_b32 v27, s18, v30
  buffer_load_dwordx4 v[40:43], v27, s[12:15], 0 offen offset:0 nt
  v_dot2c_f32_bf16_dpp v160, v80, v44 row_newbcast:12 row_mask:0xf bank_mask:0xf
  v_dot2c_f32_bf16_dpp v161, v81, v44 row_newbcast:12 row_mask:0xf bank_mask:0xf
  v_dot2c_f32_bf16_dpp v162, v80, v45 row_newbcast:12 row_mask:0xf bank_mask:0xf
  v_dot2c_f32_bf16_dpp v163, v81, v45 row_newbcast:12 row_mask:0xf bank_mask:0xf
  v_dot2c_f32_bf16_dpp v164, v80, v46 row_newbcast:12 row_mask:0xf bank_mask:0xf
  v_dot2c_f32_bf16_dpp v165, v81, v46 row_newbcast:12 row_mask:0xf bank_mask:0xf
  v_dot2c_f32_bf16_dpp v166, v80, v47 row_newbcast:12 row_mask:0xf bank_mask:0xf
  v_dot2c_f32_bf16_dpp v167, v81, v47 row_newbcast:12 row_mask:0xf bank_mask:0xf
  v_dot2c_f32_bf16_dpp v168, v84, v44 row_newbcast:12 row_mask:0xf bank_mask:0xf
  v_dot2c_f32_bf16_dpp v169, v85, v44 row_newbcast:12 row_mask:0xf bank_mask:0xf
  v_dot2c_f32_bf16_dpp v170, v84, v45 row_newbcast:12 row_mask:0xf bank_mask:0xf
  v_dot2c_f32_bf16_dpp v171, v85, v45 row_newbcast:12 row_mask:0xf bank_mask:0xf
  v_dot2c_f32_bf16_dpp v172, v84, v46 row_newbcast:12 row_mask:0xf bank_mask:0xf
  v_dot2c_f32_bf16_dpp v173, v85, v46 row_newbcast:12 row_mask:0xf bank_mask:0xf
  v_dot2c_f32_bf16_dpp v174, v84, v47 row_newbcast:12 row_mask:0xf bank_mask:0xf
  v_dot2c_f32_bf16_dpp v175, v85, v47 row_newbcast:12 row_mask:0xf bank_mask:0xf
  v_dot2c_f32_bf16_dpp v176, v88, v44 row_newbcast:12 row_mask:0xf bank_mask:0xf
  v_dot2c_f32_bf16_dpp v177, v89, v44 row_newbcast:12 row_mask:0xf bank_mask:0xf
  v_dot2c_f32_bf16_dpp v178, v88, v45 row_newbcast:12 row_mask:0xf bank_mask:0xf
  v_dot2c_f32_bf16_dpp v179, v89, v45 row_newbcast:12 row_mask:0xf bank_mask:0xf
  v_dot2c_f32_bf16_dpp v180, v88, v46 row_newbcast:12 row_mask:0xf bank_mask:0xf
  v_dot2c_f32_bf16_dpp v181, v89, v46 row_newbcast:12 row_mask:0xf bank_mask:0xf
  v_dot2c_f32_bf16_dpp v182, v88, v47 row_newbcast:12 row_mask:0xf bank_mask:0xf
  v_dot2c_f32_bf16_dpp v183, v89, v47 row_newbcast:12 row_mask:0xf bank_mask:0xf
  v_dot2c_f32_bf16_dpp v184, v92, v44 row_newbcast:12 row_mask:0xf bank_mask:0xf
  v_dot2c_f32_bf16_dpp v185, v93, v44 row_newbcast:12 row_mask:0xf bank_mask:0xf
  v_dot2c_f32_bf16_dpp v186, v92, v45 row_newbcast:12 row_mask:0xf bank_mask:0xf
  v_dot2c_f32_bf16_dpp v187, v93, v45 row_newbcast:12 row_mask:0xf bank_mask:0xf
  v_dot2c_f32_bf16_dpp v188, v92, v46 row_newbcast:12 row_mask:0xf bank_mask:0xf
  v_dot2c_f32_bf16_dpp v189, v93, v46 row_newbcast:12 row_mask:0xf bank_mask:0xf
  v_dot2c_f32_bf16_dpp v190, v92, v47 row_newbcast:12 row_mask:0xf bank_mask:0xf
  v_dot2c_f32_bf16_dpp v191, v93, v47 row_newbcast:12 row_mask:0xf bank_mask:0xf
  v_dot2c_f32_bf16_dpp v192, v96, v44 row_newbcast:12 row_mask:0xf bank_mask:0xf
  v_dot2c_f32_bf16_dpp v193, v97, v44 row_newbcast:12 row_mask:0xf bank_mask:0xf
  v_dot2c_f32_bf16_dpp v194, v96, v45 row_newbcast:12 row_mask:0xf bank_mask:0xf
  v_dot2c_f32_bf16_dpp v195, v97, v45 row_newbcast:12 row_mask:0xf bank_mask:0xf
  v_dot2c_f32_bf16_dpp v196, v96, v46 row_newbcast:12 row_mask:0xf bank_mask:0xf
  v_dot2c_f32_bf16_dpp v197, v97, v46 row_newbcast:12 row_mask:0xf bank_mask:0xf
  v_dot2c_f32_bf16_dpp v198, v96, v47 row_newbcast:12 row_mask:0xf bank_mask:0xf
  v_dot2c_f32_bf16_dpp v199, v97, v47 row_newbcast:12 row_mask:0xf bank_mask:0xf
  v_dot2c_f32_bf16_dpp v200, v100, v44 row_newbcast:12 row_mask:0xf bank_mask:0xf
  v_dot2c_f32_bf16_dpp v201, v101, v44 row_newbcast:12 row_mask:0xf bank_mask:0xf
  v_dot2c_f32_bf16_dpp v202, v100, v45 row_newbcast:12 row_mask:0xf bank_mask:0xf
  v_dot2c_f32_bf16_dpp v203, v101, v45 row_newbcast:12 row_mask:0xf bank_mask:0xf
  v_dot2c_f32_bf16_dpp v204, v100, v46 row_newbcast:12 row_mask:0xf bank_mask:0xf
  v_dot2c_f32_bf16_dpp v205, v101, v46 row_newbcast:12 row_mask:0xf bank_mask:0xf
  v_dot2c_f32_bf16_dpp v206, v100, v47 row_newbcast:12 row_mask:0xf bank_mask:0xf
  v_dot2c_f32_bf16_dpp v207, v101, v47 row_newbcast:12 row_mask:0xf bank_mask:0xf
  v_dot2c_f32_bf16_dpp v208, v104, v44 row_newbcast:12 row_mask:0xf bank_mask:0xf
  v_dot2c_f32_bf16_dpp v209, v105, v44 row_newbcast:12 row_mask:0xf bank_mask:0xf
  v_dot2c_f32_bf16_dpp v210, v104, v45 row_newbcast:12 row_mask:0xf bank_mask:0xf
  v_dot2c_f32_bf16_dpp v211, v105, v45 row_newbcast:12 row_mask:0xf bank_mask:0xf
  v_dot2c_f32_bf16_dpp v212, v104, v46 row_newbcast:12 row_mask:0xf bank_mask:0xf
  v_dot2c_f32_bf16_dpp v213, v105, v46 row_newbcast:12 row_mask:0xf bank_mask:0xf
  v_dot2c_f32_bf16_dpp v214, v104, v47 row_newbcast:12 row_mask:0xf bank_mask:0xf
  v_dot2c_f32_bf16_dpp v215, v105, v47 row_newbcast:12 row_mask:0xf bank_mask:0xf
  v_dot2c_f32_bf16_dpp v216, v108, v44 row_newbcast:12 row_mask:0xf bank_mask:0xf
  v_dot2c_f32_bf16_dpp v217, v109, v44 row_newbcast:12 row_mask:0xf bank_mask:0xf
  v_dot2c_f32_bf16_dpp v218, v108, v45 row_newbcast:12 row_mask:0xf bank_mask:0xf
  v_dot2c_f32_bf16_dpp v219, v109, v45 row_newbcast:12 row_mask:0xf bank_mask:0xf
  v_dot2c_f32_bf16_dpp v220, v108, v46 row_newbcast:12 row_mask:0xf bank_mask:0xf
  v_dot2c_f32_bf16_dpp v221, v109, v46 row_newbcast:12 row_mask:0xf bank_mask:0xf
  v_dot2c_f32_bf16_dpp v222, v108, v47 row_newbcast:12 row_mask:0xf bank_mask:0xf
  v_dot2c_f32_bf16_dpp v223, v109, v47 row_newbcast:12 row_mask:0xf bank_mask:0xf
  s_waitcnt vmcnt(6)
  v_xor_b32 v27, s19, v30
  buffer_load_dwordx4 v[44:47], v27, s[12:15], 0 offen offset:0 nt
  v_dot2c_f32_bf16_dpp v160, v82, v48 row_newbcast:0 row_mask:0xf bank_mask:0xf
  v_dot2c_f32_bf16_dpp v161, v83, v48 row_newbcast:0 row_mask:0xf bank_mask:0xf
  v_dot2c_f32_bf16_dpp v162, v82, v49 row_newbcast:0 row_mask:0xf bank_mask:0xf
  v_dot2c_f32_bf16_dpp v163, v83, v49 row_newbcast:0 row_mask:0xf bank_mask:0xf
  v_dot2c_f32_bf16_dpp v164, v82, v50 row_newbcast:0 row_mask:0xf bank_mask:0xf
  v_dot2c_f32_bf16_dpp v165, v83, v50 row_newbcast:0 row_mask:0xf bank_mask:0xf
  v_dot2c_f32_bf16_dpp v166, v82, v51 row_newbcast:0 row_mask:0xf bank_mask:0xf
  v_dot2c_f32_bf16_dpp v167, v83, v51 row_newbcast:0 row_mask:0xf bank_mask:0xf
  v_dot2c_f32_bf16_dpp v168, v86, v48 row_newbcast:0 row_mask:0xf bank_mask:0xf
  v_dot2c_f32_bf16_dpp v169, v87, v48 row_newbcast:0 row_mask:0xf bank_mask:0xf
  v_dot2c_f32_bf16_dpp v170, v86, v49 row_newbcast:0 row_mask:0xf bank_mask:0xf
  v_dot2c_f32_bf16_dpp v171, v87, v49 row_newbcast:0 row_mask:0xf bank_mask:0xf
  v_dot2c_f32_bf16_dpp v172, v86, v50 row_newbcast:0 row_mask:0xf bank_mask:0xf
  v_dot2c_f32_bf16_dpp v173, v87, v50 row_newbcast:0 row_mask:0xf bank_mask:0xf
  v_dot2c_f32_bf16_dpp v174, v86, v51 row_newbcast:0 row_mask:0xf bank_mask:0xf
  v_dot2c_f32_bf16_dpp v175, v87, v51 row_newbcast:0 row_mask:0xf bank_mask:0xf
  v_dot2c_f32_bf16_dpp v176, v90, v48 row_newbcast:0 row_mask:0xf bank_mask:0xf
  v_dot2c_f32_bf16_dpp v177, v91, v48 row_newbcast:0 row_mask:0xf bank_mask:0xf
  v_dot2c_f32_bf16_dpp v178, v90, v49 row_newbcast:0 row_mask:0xf bank_mask:0xf
  v_dot2c_f32_bf16_dpp v179, v91, v49 row_newbcast:0 row_mask:0xf bank_mask:0xf
  v_dot2c_f32_bf16_dpp v180, v90, v50 row_newbcast:0 row_mask:0xf bank_mask:0xf
  v_dot2c_f32_bf16_dpp v181, v91, v50 row_newbcast:0 row_mask:0xf bank_mask:0xf
  v_dot2c_f32_bf16_dpp v182, v90, v51 row_newbcast:0 row_mask:0xf bank_mask:0xf
  v_dot2c_f32_bf16_dpp v183, v91, v51 row_newbcast:0 row_mask:0xf bank_mask:0xf
  v_dot2c_f32_bf16_dpp v184, v94, v48 row_newbcast:0 row_mask:0xf bank_mask:0xf
  v_dot2c_f32_bf16_dpp v185, v95, v48 row_newbcast:0 row_mask:0xf bank_mask:0xf
  v_dot2c_f32_bf16_dpp v186, v94, v49 row_newbcast:0 row_mask:0xf bank_mask:0xf
  v_dot2c_f32_bf16_dpp v187, v95, v49 row_newbcast:0 row_mask:0xf bank_mask:0xf
  v_dot2c_f32_bf16_dpp v188, v94, v50 row_newbcast:0 row_mask:0xf bank_mask:0xf
  v_dot2c_f32_bf16_dpp v189, v95, v50 row_newbcast:0 row_mask:0xf bank_mask:0xf
  v_dot2c_f32_bf16_dpp v190, v94, v51 row_newbcast:0 row_mask:0xf bank_mask:0xf
  v_dot2c_f32_bf16_dpp v191, v95, v51 row_newbcast:0 row_mask:0xf bank_mask:0xf
  v_dot2c_f32_bf16_dpp v192, v98, v48 row_newbcast:0 row_mask:0xf bank_mask:0xf
  v_dot2c_f32_bf16_dpp v193, v99, v48 row_newbcast:0 row_mask:0xf bank_mask:0xf
  v_dot2c_f32_bf16_dpp v194, v98, v49 row_newbcast:0 row_mask:0xf bank_mask:0xf
  v_dot2c_f32_bf16_dpp v195, v99, v49 row_newbcast:0 row_mask:0xf bank_mask:0xf
  v_dot2c_f32_bf16_dpp v196, v98, v50 row_newbcast:0 row_mask:0xf bank_mask:0xf
  v_dot2c_f32_bf16_dpp v197, v99, v50 row_newbcast:0 row_mask:0xf bank_mask:0xf
  v_dot2c_f32_bf16_dpp v198, v98, v51 row_newbcast:0 row_mask:0xf bank_mask:0xf
  v_dot2c_f32_bf16_dpp v199, v99, v51 row_newbcast:0 row_mask:0xf bank_mask:0xf
  v_dot2c_f32_bf16_dpp v200, v102, v48 row_newbcast:0 row_mask:0xf bank_mask:0xf
  v_dot2c_f32_bf16_dpp v201, v103, v48 row_newbcast:0 row_mask:0xf bank_mask:0xf
  v_dot2c_f32_bf16_dpp v202, v102, v49 row_newbcast:0 row_mask:0xf bank_mask:0xf
  v_dot2c_f32_bf16_dpp v203, v103, v49 row_newbcast:0 row_mask:0xf bank_mask:0xf
  v_dot2c_f32_bf16_dpp v204, v102, v50 row_newbcast:0 row_mask:0xf bank_mask:0xf
  v_dot2c_f32_bf16_dpp v205, v103, v50 row_newbcast:0 row_mask:0xf bank_mask:0xf
  v_dot2c_f32_bf16_dpp v206, v102, v51 row_newbcast:0 row_mask:0xf bank_mask:0xf
  v_dot2c_f32_bf16_dpp v207, v103, v51 row_newbcast:0 row_mask:0xf bank_mask:0xf
  v_dot2c_f32_bf16_dpp v208, v106, v48 row_newbcast:0 row_mask:0xf bank_mask:0xf
  v_dot2c_f32_bf16_dpp v209, v107, v48 row_newbcast:0 row_mask:0xf bank_mask:0xf
  v_dot2c_f32_bf16_dpp v210, v106, v49 row_newbcast:0 row_mask:0xf bank_mask:0xf
  v_dot2c_f32_bf16_dpp v211, v107, v49 row_newbcast:0 row_mask:0xf bank_mask:0xf
  v_dot2c_f32_bf16_dpp v212, v106, v50 row_newbcast:0 row_mask:0xf bank_mask:0xf
  v_dot2c_f32_bf16_dpp v213, v107, v50 row_newbcast:0 row_mask:0xf bank_mask:0xf
  v_dot2c_f32_bf16_dpp v214, v106, v51 row_newbcast:0 row_mask:0xf bank_mask:0xf
  v_dot2c_f32_bf16_dpp v215, v107, v51 row_newbcast:0 row_mask:0xf bank_mask:0xf
  v_dot2c_f32_bf16_dpp v216, v110, v48 row_newbcast:0 row_mask:0xf bank_mask:0xf
  v_dot2c_f32_bf16_dpp v217, v111, v48 row_newbcast:0 row_mask:0xf bank_mask:0xf
  v_dot2c_f32_bf16_dpp v218, v110, v49 row_newbcast:0 row_mask:0xf bank_mask:0xf
  v_dot2c_f32_bf16_dpp v219, v111, v49 row_newbcast:0 row_mask:0xf bank_mask:0xf
  v_dot2c_f32_bf16_dpp v220, v110, v50 row_newbcast:0 row_mask:0xf bank_mask:0xf
  v_dot2c_f32_bf16_dpp v221, v111, v50 row_newbcast:0 row_mask:0xf bank_mask:0xf
  v_dot2c_f32_bf16_dpp v222, v110, v51 row_newbcast:0 row_mask:0xf bank_mask:0xf
  v_dot2c_f32_bf16_dpp v223, v111, v51 row_newbcast:0 row_mask:0xf bank_mask:0xf
  s_waitcnt vmcnt(6)
  v_xor_b32 v27, s20, v30
  buffer_load_dwordx4 v[48:51], v27, s[12:15], 0 offen offset:0 nt
  v_dot2c_f32_bf16_dpp v160, v82, v52 row_newbcast:8 row_mask:0xf bank_mask:0xf
  v_dot2c_f32_bf16_dpp v161, v83, v52 row_newbcast:8 row_mask:0xf bank_mask:0xf
  v_dot2c_f32_bf16_dpp v162, v82, v53 row_newbcast:8 row_mask:0xf bank_mask:0xf
  v_dot2c_f32_bf16_dpp v163, v83, v53 row_newbcast:8 row_mask:0xf bank_mask:0xf
  v_dot2c_f32_bf16_dpp v164, v82, v54 row_newbcast:8 row_mask:0xf bank_mask:0xf
  v_dot2c_f32_bf16_dpp v165, v83, v54 row_newbcast:8 row_mask:0xf bank_mask:0xf
  v_dot2c_f32_bf16_dpp v166, v82, v55 row_newbcast:8 row_mask:0xf bank_mask:0xf
  v_dot2c_f32_bf16_dpp v167, v83, v55 row_newbcast:8 row_mask:0xf bank_mask:0xf
  v_dot2c_f32_bf16_dpp v168, v86, v52 row_newbcast:8 row_mask:0xf bank_mask:0xf
  v_dot2c_f32_bf16_dpp v169, v87, v52 row_newbcast:8 row_mask:0xf bank_mask:0xf
  v_dot2c_f32_bf16_dpp v170, v86, v53 row_newbcast:8 row_mask:0xf bank_mask:0xf
  v_dot2c_f32_bf16_dpp v171, v87, v53 row_newbcast:8 row_mask:0xf bank_mask:0xf
  v_dot2c_f32_bf16_dpp v172, v86, v54 row_newbcast:8 row_mask:0xf bank_mask:0xf
  v_dot2c_f32_bf16_dpp v173, v87, v54 row_newbcast:8 row_mask:0xf bank_mask:0xf
  v_dot2c_f32_bf16_dpp v174, v86, v55 row_newbcast:8 row_mask:0xf bank_mask:0xf
  v_dot2c_f32_bf16_dpp v175, v87, v55 row_newbcast:8 row_mask:0xf bank_mask:0xf
  v_dot2c_f32_bf16_dpp v176, v90, v52 row_newbcast:8 row_mask:0xf bank_mask:0xf
  v_dot2c_f32_bf16_dpp v177, v91, v52 row_newbcast:8 row_mask:0xf bank_mask:0xf
  v_dot2c_f32_bf16_dpp v178, v90, v53 row_newbcast:8 row_mask:0xf bank_mask:0xf
  v_dot2c_f32_bf16_dpp v179, v91, v53 row_newbcast:8 row_mask:0xf bank_mask:0xf
  v_dot2c_f32_bf16_dpp v180, v90, v54 row_newbcast:8 row_mask:0xf bank_mask:0xf
  v_dot2c_f32_bf16_dpp v181, v91, v54 row_newbcast:8 row_mask:0xf bank_mask:0xf
  v_dot2c_f32_bf16_dpp v182, v90, v55 row_newbcast:8 row_mask:0xf bank_mask:0xf
  v_dot2c_f32_bf16_dpp v183, v91, v55 row_newbcast:8 row_mask:0xf bank_mask:0xf
  v_dot2c_f32_bf16_dpp v184, v94, v52 row_newbcast:8 row_mask:0xf bank_mask:0xf
  v_dot2c_f32_bf16_dpp v185, v95, v52 row_newbcast:8 row_mask:0xf bank_mask:0xf
  v_dot2c_f32_bf16_dpp v186, v94, v53 row_newbcast:8 row_mask:0xf bank_mask:0xf
  v_dot2c_f32_bf16_dpp v187, v95, v53 row_newbcast:8 row_mask:0xf bank_mask:0xf
  v_dot2c_f32_bf16_dpp v188, v94, v54 row_newbcast:8 row_mask:0xf bank_mask:0xf
  v_dot2c_f32_bf16_dpp v189, v95, v54 row_newbcast:8 row_mask:0xf bank_mask:0xf
  v_dot2c_f32_bf16_dpp v190, v94, v55 row_newbcast:8 row_mask:0xf bank_mask:0xf
  v_dot2c_f32_bf16_dpp v191, v95, v55 row_newbcast:8 row_mask:0xf bank_mask:0xf
  v_dot2c_f32_bf16_dpp v192, v98, v52 row_newbcast:8 row_mask:0xf bank_mask:0xf
  v_dot2c_f32_bf16_dpp v193, v99, v52 row_newbcast:8 row_mask:0xf bank_mask:0xf
  v_dot2c_f32_bf16_dpp v194, v98, v53 row_newbcast:8 row_mask:0xf bank_mask:0xf
  v_dot2c_f32_bf16_dpp v195, v99, v53 row_newbcast:8 row_mask:0xf bank_mask:0xf
  v_dot2c_f32_bf16_dpp v196, v98, v54 row_newbcast:8 row_mask:0xf bank_mask:0xf
  v_dot2c_f32_bf16_dpp v197, v99, v54 row_newbcast:8 row_mask:0xf bank_mask:0xf
  v_dot2c_f32_bf16_dpp v198, v98, v55 row_newbcast:8 row_mask:0xf bank_mask:0xf
  v_dot2c_f32_bf16_dpp v199, v99, v55 row_newbcast:8 row_mask:0xf bank_mask:0xf
  v_dot2c_f32_bf16_dpp v200, v102, v52 row_newbcast:8 row_mask:0xf bank_mask:0xf
  v_dot2c_f32_bf16_dpp v201, v103, v52 row_newbcast:8 row_mask:0xf bank_mask:0xf
  v_dot2c_f32_bf16_dpp v202, v102, v53 row_newbcast:8 row_mask:0xf bank_mask:0xf
  v_dot2c_f32_bf16_dpp v203, v103, v53 row_newbcast:8 row_mask:0xf bank_mask:0xf
  v_dot2c_f32_bf16_dpp v204, v102, v54 row_newbcast:8 row_mask:0xf bank_mask:0xf
  v_dot2c_f32_bf16_dpp v205, v103, v54 row_newbcast:8 row_mask:0xf bank_mask:0xf
  v_dot2c_f32_bf16_dpp v206, v102, v55 row_newbcast:8 row_mask:0xf bank_mask:0xf
  v_dot2c_f32_bf16_dpp v207, v103, v55 row_newbcast:8 row_mask:0xf bank_mask:0xf
  v_dot2c_f32_bf16_dpp v208, v106, v52 row_newbcast:8 row_mask:0xf bank_mask:0xf
  v_dot2c_f32_bf16_dpp v209, v107, v52 row_newbcast:8 row_mask:0xf bank_mask:0xf
  v_dot2c_f32_bf16_dpp v210, v106, v53 row_newbcast:8 row_mask:0xf bank_mask:0xf
  v_dot2c_f32_bf16_dpp v211, v107, v53 row_newbcast:8 row_mask:0xf bank_mask:0xf
  v_dot2c_f32_bf16_dpp v212, v106, v54 row_newbcast:8 row_mask:0xf bank_mask:0xf
  v_dot2c_f32_bf16_dpp v213, v107, v54 row_newbcast:8 row_mask:0xf bank_mask:0xf
  v_dot2c_f32_bf16_dpp v214, v106, v55 row_newbcast:8 row_mask:0xf bank_mask:0xf
  v_dot2c_f32_bf16_dpp v215, v107, v55 row_newbcast:8 row_mask:0xf bank_mask:0xf
  v_dot2c_f32_bf16_dpp v216, v110, v52 row_newbcast:8 row_mask:0xf bank_mask:0xf
  v_dot2c_f32_bf16_dpp v217, v111, v52 row_newbcast:8 row_mask:0xf bank_mask:0xf
  v_dot2c_f32_bf16_dpp v218, v110, v53 row_newbcast:8 row_mask:0xf bank_mask:0xf
  v_dot2c_f32_bf16_dpp v219, v111, v53 row_newbcast:8 row_mask:0xf bank_mask:0xf
  v_dot2c_f32_bf16_dpp v220, v110, v54 row_newbcast:8 row_mask:0xf bank_mask:0xf
  v_dot2c_f32_bf16_dpp v221, v111, v54 row_newbcast:8 row_mask:0xf bank_mask:0xf
  v_dot2c_f32_bf16_dpp v222, v110, v55 row_newbcast:8 row_mask:0xf bank_mask:0xf
  v_dot2c_f32_bf16_dpp v223, v111, v55 row_newbcast:8 row_mask:0xf bank_mask:0xf
  s_waitcnt vmcnt(6)
  v_dot2c_f32_bf16_dpp v160, v82, v56 row_newbcast:4 row_mask:0xf bank_mask:0xf
  v_dot2c_f32_bf16_dpp v161, v83, v56 row_newbcast:4 row_mask:0xf bank_mask:0xf
  v_dot2c_f32_bf16_dpp v162, v82, v57 row_newbcast:4 row_mask:0xf bank_mask:0xf
  v_dot2c_f32_bf16_dpp v163, v83, v57 row_newbcast:4 row_mask:0xf bank_mask:0xf
  v_dot2c_f32_bf16_dpp v164, v82, v58 row_newbcast:4 row_mask:0xf bank_mask:0xf
  v_dot2c_f32_bf16_dpp v165, v83, v58 row_newbcast:4 row_mask:0xf bank_mask:0xf
  v_dot2c_f32_bf16_dpp v166, v82, v59 row_newbcast:4 row_mask:0xf bank_mask:0xf
  v_dot2c_f32_bf16_dpp v167, v83, v59 row_newbcast:4 row_mask:0xf bank_mask:0xf
  v_dot2c_f32_bf16_dpp v168, v86, v56 row_newbcast:4 row_mask:0xf bank_mask:0xf
  v_dot2c_f32_bf16_dpp v169, v87, v56 row_newbcast:4 row_mask:0xf bank_mask:0xf
  v_dot2c_f32_bf16_dpp v170, v86, v57 row_newbcast:4 row_mask:0xf bank_mask:0xf
  v_dot2c_f32_bf16_dpp v171, v87, v57 row_newbcast:4 row_mask:0xf bank_mask:0xf
  v_dot2c_f32_bf16_dpp v172, v86, v58 row_newbcast:4 row_mask:0xf bank_mask:0xf
  v_dot2c_f32_bf16_dpp v173, v87, v58 row_newbcast:4 row_mask:0xf bank_mask:0xf
  v_dot2c_f32_bf16_dpp v174, v86, v59 row_newbcast:4 row_mask:0xf bank_mask:0xf
  v_dot2c_f32_bf16_dpp v175, v87, v59 row_newbcast:4 row_mask:0xf bank_mask:0xf
  v_dot2c_f32_bf16_dpp v176, v90, v56 row_newbcast:4 row_mask:0xf bank_mask:0xf
  v_dot2c_f32_bf16_dpp v177, v91, v56 row_newbcast:4 row_mask:0xf bank_mask:0xf
  v_dot2c_f32_bf16_dpp v178, v90, v57 row_newbcast:4 row_mask:0xf bank_mask:0xf
  v_dot2c_f32_bf16_dpp v179, v91, v57 row_newbcast:4 row_mask:0xf bank_mask:0xf
  v_dot2c_f32_bf16_dpp v180, v90, v58 row_newbcast:4 row_mask:0xf bank_mask:0xf
  v_dot2c_f32_bf16_dpp v181, v91, v58 row_newbcast:4 row_mask:0xf bank_mask:0xf
  v_dot2c_f32_bf16_dpp v182, v90, v59 row_newbcast:4 row_mask:0xf bank_mask:0xf
  v_dot2c_f32_bf16_dpp v183, v91, v59 row_newbcast:4 row_mask:0xf bank_mask:0xf
  v_dot2c_f32_bf16_dpp v184, v94, v56 row_newbcast:4 row_mask:0xf bank_mask:0xf
  v_dot2c_f32_bf16_dpp v185, v95, v56 row_newbcast:4 row_mask:0xf bank_mask:0xf
  v_dot2c_f32_bf16_dpp v186, v94, v57 row_newbcast:4 row_mask:0xf bank_mask:0xf
  v_dot2c_f32_bf16_dpp v187, v95, v57 row_newbcast:4 row_mask:0xf bank_mask:0xf
  v_dot2c_f32_bf16_dpp v188, v94, v58 row_newbcast:4 row_mask:0xf bank_mask:0xf
  v_dot2c_f32_bf16_dpp v189, v95, v58 row_newbcast:4 row_mask:0xf bank_mask:0xf
  v_dot2c_f32_bf16_dpp v190, v94, v59 row_newbcast:4 row_mask:0xf bank_mask:0xf
  v_dot2c_f32_bf16_dpp v191, v95, v59 row_newbcast:4 row_mask:0xf bank_mask:0xf
  v_dot2c_f32_bf16_dpp v192, v98, v56 row_newbcast:4 row_mask:0xf bank_mask:0xf
  v_dot2c_f32_bf16_dpp v193, v99, v56 row_newbcast:4 row_mask:0xf bank_mask:0xf
  v_dot2c_f32_bf16_dpp v194, v98, v57 row_newbcast:4 row_mask:0xf bank_mask:0xf
  v_dot2c_f32_bf16_dpp v195, v99, v57 row_newbcast:4 row_mask:0xf bank_mask:0xf
  v_dot2c_f32_bf16_dpp v196, v98, v58 row_newbcast:4 row_mask:0xf bank_mask:0xf
  v_dot2c_f32_bf16_dpp v197, v99, v58 row_newbcast:4 row_mask:0xf bank_mask:0xf
  v_dot2c_f32_bf16_dpp v198, v98, v59 row_newbcast:4 row_mask:0xf bank_mask:0xf
  v_dot2c_f32_bf16_dpp v199, v99, v59 row_newbcast:4 row_mask:0xf bank_mask:0xf
  v_dot2c_f32_bf16_dpp v200, v102, v56 row_newbcast:4 row_mask:0xf bank_mask:0xf
  v_dot2c_f32_bf16_dpp v201, v103, v56 row_newbcast:4 row_mask:0xf bank_mask:0xf
  v_dot2c_f32_bf16_dpp v202, v102, v57 row_newbcast:4 row_mask:0xf bank_mask:0xf
  v_dot2c_f32_bf16_dpp v203, v103, v57 row_newbcast:4 row_mask:0xf bank_mask:0xf
  v_dot2c_f32_bf16_dpp v204, v102, v58 row_newbcast:4 row_mask:0xf bank_mask:0xf
  v_dot2c_f32_bf16_dpp v205, v103, v58 row_newbcast:4 row_mask:0xf bank_mask:0xf
  v_dot2c_f32_bf16_dpp v206, v102, v59 row_newbcast:4 row_mask:0xf bank_mask:0xf
  v_dot2c_f32_bf16_dpp v207, v103, v59 row_newbcast:4 row_mask:0xf bank_mask:0xf
  v_dot2c_f32_bf16_dpp v208, v106, v56 row_newbcast:4 row_mask:0xf bank_mask:0xf
  v_dot2c_f32_bf16_dpp v209, v107, v56 row_newbcast:4 row_mask:0xf bank_mask:0xf
  v_dot2c_f32_bf16_dpp v210, v106, v57 row_newbcast:4 row_mask:0xf bank_mask:0xf
  v_dot2c_f32_bf16_dpp v211, v107, v57 row_newbcast:4 row_mask:0xf bank_mask:0xf
  v_dot2c_f32_bf16_dpp v212, v106, v58 row_newbcast:4 row_mask:0xf bank_mask:0xf
  v_dot2c_f32_bf16_dpp v213, v107, v58 row_newbcast:4 row_mask:0xf bank_mask:0xf
  v_dot2c_f32_bf16_dpp v214, v106, v59 row_newbcast:4 row_mask:0xf bank_mask:0xf
  v_dot2c_f32_bf16_dpp v215, v107, v59 row_newbcast:4 row_mask:0xf bank_mask:0xf
  v_dot2c_f32_bf16_dpp v216, v110, v56 row_newbcast:4 row_mask:0xf bank_mask:0xf
  v_dot2c_f32_bf16_dpp v217, v111, v56 row_newbcast:4 row_mask:0xf bank_mask:0xf
  v_dot2c_f32_bf16_dpp v218, v110, v57 row_newbcast:4 row_mask:0xf bank_mask:0xf
  v_dot2c_f32_bf16_dpp v219, v111, v57 row_newbcast:4 row_mask:0xf bank_mask:0xf
  v_dot2c_f32_bf16_dpp v220, v110, v58 row_newbcast:4 row_mask:0xf bank_mask:0xf
  v_dot2c_f32_bf16_dpp v221, v111, v58 row_newbcast:4 row_mask:0xf bank_mask:0xf
  v_dot2c_f32_bf16_dpp v222, v110, v59 row_newbcast:4 row_mask:0xf bank_mask:0xf
  v_dot2c_f32_bf16_dpp v223, v111, v59 row_newbcast:4 row_mask:0xf bank_mask:0xf
  s_waitcnt vmcnt(5)
  v_dot2c_f32_bf16_dpp v160, v82, v60 row_newbcast:12 row_mask:0xf bank_mask:0xf
  v_dot2c_f32_bf16_dpp v161, v83, v60 row_newbcast:12 row_mask:0xf bank_mask:0xf
  v_dot2c_f32_bf16_dpp v162, v82, v61 row_newbcast:12 row_mask:0xf bank_mask:0xf
  v_dot2c_f32_bf16_dpp v163, v83, v61 row_newbcast:12 row_mask:0xf bank_mask:0xf
  v_dot2c_f32_bf16_dpp v164, v82, v62 row_newbcast:12 row_mask:0xf bank_mask:0xf
  v_dot2c_f32_bf16_dpp v165, v83, v62 row_newbcast:12 row_mask:0xf bank_mask:0xf
  v_dot2c_f32_bf16_dpp v166, v82, v63 row_newbcast:12 row_mask:0xf bank_mask:0xf
  v_dot2c_f32_bf16_dpp v167, v83, v63 row_newbcast:12 row_mask:0xf bank_mask:0xf
  v_dot2c_f32_bf16_dpp v168, v86, v60 row_newbcast:12 row_mask:0xf bank_mask:0xf
  v_dot2c_f32_bf16_dpp v169, v87, v60 row_newbcast:12 row_mask:0xf bank_mask:0xf
  v_dot2c_f32_bf16_dpp v170, v86, v61 row_newbcast:12 row_mask:0xf bank_mask:0xf
  v_dot2c_f32_bf16_dpp v171, v87, v61 row_newbcast:12 row_mask:0xf bank_mask:0xf
  v_dot2c_f32_bf16_dpp v172, v86, v62 row_newbcast:12 row_mask:0xf bank_mask:0xf
  v_dot2c_f32_bf16_dpp v173, v87, v62 row_newbcast:12 row_mask:0xf bank_mask:0xf
  v_dot2c_f32_bf16_dpp v174, v86, v63 row_newbcast:12 row_mask:0xf bank_mask:0xf
  v_dot2c_f32_bf16_dpp v175, v87, v63 row_newbcast:12 row_mask:0xf bank_mask:0xf
  v_dot2c_f32_bf16_dpp v176, v90, v60 row_newbcast:12 row_mask:0xf bank_mask:0xf
  v_dot2c_f32_bf16_dpp v177, v91, v60 row_newbcast:12 row_mask:0xf bank_mask:0xf
  v_dot2c_f32_bf16_dpp v178, v90, v61 row_newbcast:12 row_mask:0xf bank_mask:0xf
  v_dot2c_f32_bf16_dpp v179, v91, v61 row_newbcast:12 row_mask:0xf bank_mask:0xf
  v_dot2c_f32_bf16_dpp v180, v90, v62 row_newbcast:12 row_mask:0xf bank_mask:0xf
  v_dot2c_f32_bf16_dpp v181, v91, v62 row_newbcast:12 row_mask:0xf bank_mask:0xf
  v_dot2c_f32_bf16_dpp v182, v90, v63 row_newbcast:12 row_mask:0xf bank_mask:0xf
  v_dot2c_f32_bf16_dpp v183, v91, v63 row_newbcast:12 row_mask:0xf bank_mask:0xf
  v_dot2c_f32_bf16_dpp v184, v94, v60 row_newbcast:12 row_mask:0xf bank_mask:0xf
  v_dot2c_f32_bf16_dpp v185, v95, v60 row_newbcast:12 row_mask:0xf bank_mask:0xf
  v_dot2c_f32_bf16_dpp v186, v94, v61 row_newbcast:12 row_mask:0xf bank_mask:0xf
  v_dot2c_f32_bf16_dpp v187, v95, v61 row_newbcast:12 row_mask:0xf bank_mask:0xf
  v_dot2c_f32_bf16_dpp v188, v94, v62 row_newbcast:12 row_mask:0xf bank_mask:0xf
  v_dot2c_f32_bf16_dpp v189, v95, v62 row_newbcast:12 row_mask:0xf bank_mask:0xf
  v_dot2c_f32_bf16_dpp v190, v94, v63 row_newbcast:12 row_mask:0xf bank_mask:0xf
  v_dot2c_f32_bf16_dpp v191, v95, v63 row_newbcast:12 row_mask:0xf bank_mask:0xf
  v_dot2c_f32_bf16_dpp v192, v98, v60 row_newbcast:12 row_mask:0xf bank_mask:0xf
  v_dot2c_f32_bf16_dpp v193, v99, v60 row_newbcast:12 row_mask:0xf bank_mask:0xf
  v_dot2c_f32_bf16_dpp v194, v98, v61 row_newbcast:12 row_mask:0xf bank_mask:0xf
  v_dot2c_f32_bf16_dpp v195, v99, v61 row_newbcast:12 row_mask:0xf bank_mask:0xf
  v_dot2c_f32_bf16_dpp v196, v98, v62 row_newbcast:12 row_mask:0xf bank_mask:0xf
  v_dot2c_f32_bf16_dpp v197, v99, v62 row_newbcast:12 row_mask:0xf bank_mask:0xf
  v_dot2c_f32_bf16_dpp v198, v98, v63 row_newbcast:12 row_mask:0xf bank_mask:0xf
  v_dot2c_f32_bf16_dpp v199, v99, v63 row_newbcast:12 row_mask:0xf bank_mask:0xf
  v_dot2c_f32_bf16_dpp v200, v102, v60 row_newbcast:12 row_mask:0xf bank_mask:0xf
  v_dot2c_f32_bf16_dpp v201, v103, v60 row_newbcast:12 row_mask:0xf bank_mask:0xf
  v_dot2c_f32_bf16_dpp v202, v102, v61 row_newbcast:12 row_mask:0xf bank_mask:0xf
  v_dot2c_f32_bf16_dpp v203, v103, v61 row_newbcast:12 row_mask:0xf bank_mask:0xf
  v_dot2c_f32_bf16_dpp v204, v102, v62 row_newbcast:12 row_mask:0xf bank_mask:0xf
  v_dot2c_f32_bf16_dpp v205, v103, v62 row_newbcast:12 row_mask:0xf bank_mask:0xf
  v_dot2c_f32_bf16_dpp v206, v102, v63 row_newbcast:12 row_mask:0xf bank_mask:0xf
  v_dot2c_f32_bf16_dpp v207, v103, v63 row_newbcast:12 row_mask:0xf bank_mask:0xf
  v_dot2c_f32_bf16_dpp v208, v106, v60 row_newbcast:12 row_mask:0xf bank_mask:0xf
  v_dot2c_f32_bf16_dpp v209, v107, v60 row_newbcast:12 row_mask:0xf bank_mask:0xf
  v_dot2c_f32_bf16_dpp v210, v106, v61 row_newbcast:12 row_mask:0xf bank_mask:0xf
  v_dot2c_f32_bf16_dpp v211, v107, v61 row_newbcast:12 row_mask:0xf bank_mask:0xf
  v_dot2c_f32_bf16_dpp v212, v106, v62 row_newbcast:12 row_mask:0xf bank_mask:0xf
  v_dot2c_f32_bf16_dpp v213, v107, v62 row_newbcast:12 row_mask:0xf bank_mask:0xf
  v_dot2c_f32_bf16_dpp v214, v106, v63 row_newbcast:12 row_mask:0xf bank_mask:0xf
  v_dot2c_f32_bf16_dpp v215, v107, v63 row_newbcast:12 row_mask:0xf bank_mask:0xf
  v_dot2c_f32_bf16_dpp v216, v110, v60 row_newbcast:12 row_mask:0xf bank_mask:0xf
  v_dot2c_f32_bf16_dpp v217, v111, v60 row_newbcast:12 row_mask:0xf bank_mask:0xf
  v_dot2c_f32_bf16_dpp v218, v110, v61 row_newbcast:12 row_mask:0xf bank_mask:0xf
  v_dot2c_f32_bf16_dpp v219, v111, v61 row_newbcast:12 row_mask:0xf bank_mask:0xf
  v_dot2c_f32_bf16_dpp v220, v110, v62 row_newbcast:12 row_mask:0xf bank_mask:0xf
  v_dot2c_f32_bf16_dpp v221, v111, v62 row_newbcast:12 row_mask:0xf bank_mask:0xf
  v_dot2c_f32_bf16_dpp v222, v110, v63 row_newbcast:12 row_mask:0xf bank_mask:0xf
  v_dot2c_f32_bf16_dpp v223, v111, v63 row_newbcast:12 row_mask:0xf bank_mask:0xf
  s_mov_b32 s87, s25
  v_add_u32 v248, 1024, v248
  s_cmp_eq_u32 s31, 0
  s_cbranch_scc0 L_av
  v_mov_b32 v246, v224
  v_mov_b32 v247, v224
  s_nop 1
  v_permlane32_swap_b32 v246, v247
  v_max_f32 v246, v246, v247
  v_mov_b32 v247, v246
  s_nop 1
  v_permlane16_swap_b32 v246, v247
  v_max_f32 v244, v246, v247
  v_sub_f32 v26, v224, v244
  v_exp_f32 v26, v26
  v_add_f32_dpp v22, v232, v232 row_ror:4 row_mask:0xf bank_mask:0xf
  v_pk_mul_f32 v[160:161], v[160:161], v[26:27] op_sel_hi:[1,0]
  v_pk_mul_f32 v[162:163], v[162:163], v[26:27] op_sel_hi:[1,0]
  v_pk_mul_f32 v[164:165], v[164:165], v[26:27] op_sel_hi:[1,0]
  v_pk_mul_f32 v[166:167], v[166:167], v[26:27] op_sel_hi:[1,0]
  v_add_f32_dpp v22, v22, v22 row_ror:8 row_mask:0xf bank_mask:0xf
  v_mul_f32 v22, v22, v26
  v_mov_b32 v246, v22
  v_mov_b32 v247, v22
  s_nop 1
  v_permlane32_swap_b32 v246, v247
  v_add_f32 v246, v246, v247
  v_mov_b32 v247, v246
  s_nop 1
  v_permlane16_swap_b32 v246, v247
  v_add_f32 v245, v246, v247
  ds_write_b64 v241, v[244:245] offset:10880
  v_permlane32_swap_b32 v160, v164
  v_permlane32_swap_b32 v162, v166
  v_permlane32_swap_b32 v161, v165
  v_permlane32_swap_b32 v163, v167
  v_add_f32 v160, v160, v164
  v_add_f32 v162, v162, v166
  v_add_f32 v161, v161, v165
  v_add_f32 v163, v163, v167
  v_permlane16_swap_b32 v160, v162
  s_nop 0
  v_permlane16_swap_b32 v161, v163
  v_add_f32 v160, v160, v162
  v_add_f32 v161, v161, v163
  ds_write_b64 v240, v[160:161] offset:10880
  v_mov_b32 v246, v225
  v_mov_b32 v247, v225
  s_nop 1
  v_permlane32_swap_b32 v246, v247
  v_max_f32 v246, v246, v247
  v_mov_b32 v247, v246
  s_nop 1
  v_permlane16_swap_b32 v246, v247
  v_max_f32 v244, v246, v247
  v_sub_f32 v26, v225, v244
  v_exp_f32 v26, v26
  v_add_f32_dpp v22, v233, v233 row_ror:4 row_mask:0xf bank_mask:0xf
  v_pk_mul_f32 v[168:169], v[168:169], v[26:27] op_sel_hi:[1,0]
  v_pk_mul_f32 v[170:171], v[170:171], v[26:27] op_sel_hi:[1,0]
  v_pk_mul_f32 v[172:173], v[172:173], v[26:27] op_sel_hi:[1,0]
  v_pk_mul_f32 v[174:175], v[174:175], v[26:27] op_sel_hi:[1,0]
  v_add_f32_dpp v22, v22, v22 row_ror:8 row_mask:0xf bank_mask:0xf
  v_mul_f32 v22, v22, v26
  v_mov_b32 v246, v22
  v_mov_b32 v247, v22
  s_nop 1
  v_permlane32_swap_b32 v246, v247
  v_add_f32 v246, v246, v247
  v_mov_b32 v247, v246
  s_nop 1
  v_permlane16_swap_b32 v246, v247
  v_add_f32 v245, v246, v247
  ds_write_b64 v241, v[244:245] offset:13056
  v_permlane32_swap_b32 v168, v172
  v_permlane32_swap_b32 v170, v174
  v_permlane32_swap_b32 v169, v173
  v_permlane32_swap_b32 v171, v175
  v_add_f32 v168, v168, v172
  v_add_f32 v170, v170, v174
  v_add_f32 v169, v169, v173
  v_add_f32 v171, v171, v175
  v_permlane16_swap_b32 v168, v170
  s_nop 0
  v_permlane16_swap_b32 v169, v171
  v_add_f32 v168, v168, v170
  v_add_f32 v169, v169, v171
  ds_write_b64 v240, v[168:169] offset:13056
  v_mov_b32 v246, v226
  v_mov_b32 v247, v226
  s_nop 1
  v_permlane32_swap_b32 v246, v247
  v_max_f32 v246, v246, v247
  v_mov_b32 v247, v246
  s_nop 1
  v_permlane16_swap_b32 v246, v247
  v_max_f32 v244, v246, v247
  v_sub_f32 v26, v226, v244
  v_exp_f32 v26, v26
  v_add_f32_dpp v22, v234, v234 row_ror:4 row_mask:0xf bank_mask:0xf
  v_pk_mul_f32 v[176:177], v[176:177], v[26:27] op_sel_hi:[1,0]
  v_pk_mul_f32 v[178:179], v[178:179], v[26:27] op_sel_hi:[1,0]
  v_pk_mul_f32 v[180:181], v[180:181], v[26:27] op_sel_hi:[1,0]
  v_pk_mul_f32 v[182:183], v[182:183], v[26:27] op_sel_hi:[1,0]
  v_add_f32_dpp v22, v22, v22 row_ror:8 row_mask:0xf bank_mask:0xf
  v_mul_f32 v22, v22, v26
  v_mov_b32 v246, v22
  v_mov_b32 v247, v22
  s_nop 1
  v_permlane32_swap_b32 v246, v247
  v_add_f32 v246, v246, v247
  v_mov_b32 v247, v246
  s_nop 1
  v_permlane16_swap_b32 v246, v247
  v_add_f32 v245, v246, v247
  ds_write_b64 v241, v[244:245] offset:15232
  v_permlane32_swap_b32 v176, v180
  v_permlane32_swap_b32 v178, v182
  v_permlane32_swap_b32 v177, v181
  v_permlane32_swap_b32 v179, v183
  v_add_f32 v176, v176, v180
  v_add_f32 v178, v178, v182
  v_add_f32 v177, v177, v181
  v_add_f32 v179, v179, v183
  v_permlane16_swap_b32 v176, v178
  s_nop 0
  v_permlane16_swap_b32 v177, v179
  v_add_f32 v176, v176, v178
  v_add_f32 v177, v177, v179
  ds_write_b64 v240, v[176:177] offset:15232
  v_mov_b32 v246, v227
  v_mov_b32 v247, v227
  s_nop 1
  v_permlane32_swap_b32 v246, v247
  v_max_f32 v246, v246, v247
  v_mov_b32 v247, v246
  s_nop 1
  v_permlane16_swap_b32 v246, v247
  v_max_f32 v244, v246, v247
  v_sub_f32 v26, v227, v244
  v_exp_f32 v26, v26
  v_add_f32_dpp v22, v235, v235 row_ror:4 row_mask:0xf bank_mask:0xf
  v_pk_mul_f32 v[184:185], v[184:185], v[26:27] op_sel_hi:[1,0]
  v_pk_mul_f32 v[186:187], v[186:187], v[26:27] op_sel_hi:[1,0]
  v_pk_mul_f32 v[188:189], v[188:189], v[26:27] op_sel_hi:[1,0]
  v_pk_mul_f32 v[190:191], v[190:191], v[26:27] op_sel_hi:[1,0]
  v_add_f32_dpp v22, v22, v22 row_ror:8 row_mask:0xf bank_mask:0xf
  v_mul_f32 v22, v22, v26
  v_mov_b32 v246, v22
  v_mov_b32 v247, v22
  s_nop 1
  v_permlane32_swap_b32 v246, v247
  v_add_f32 v246, v246, v247
  v_mov_b32 v247, v246
  s_nop 1
  v_permlane16_swap_b32 v246, v247
  v_add_f32 v245, v246, v247
  ds_write_b64 v241, v[244:245] offset:17408
  v_permlane32_swap_b32 v184, v188
  v_permlane32_swap_b32 v186, v190
  v_permlane32_swap_b32 v185, v189
  v_permlane32_swap_b32 v187, v191
  v_add_f32 v184, v184, v188
  v_add_f32 v186, v186, v190
  v_add_f32 v185, v185, v189
  v_add_f32 v187, v187, v191
  v_permlane16_swap_b32 v184, v186
  s_nop 0
  v_permlane16_swap_b32 v185, v187
  v_add_f32 v184, v184, v186
  v_add_f32 v185, v185, v187
  ds_write_b64 v240, v[184:185] offset:17408
  v_mov_b32 v246, v228
  v_mov_b32 v247, v228
  s_nop 1
  v_permlane32_swap_b32 v246, v247
  v_max_f32 v246, v246, v247
  v_mov_b32 v247, v246
  s_nop 1
  v_permlane16_swap_b32 v246, v247
  v_max_f32 v244, v246, v247
  v_sub_f32 v26, v228, v244
  v_exp_f32 v26, v26
  v_add_f32_dpp v22, v236, v236 row_ror:4 row_mask:0xf bank_mask:0xf
  v_pk_mul_f32 v[192:193], v[192:193], v[26:27] op_sel_hi:[1,0]
  v_pk_mul_f32 v[194:195], v[194:195], v[26:27] op_sel_hi:[1,0]
  v_pk_mul_f32 v[196:197], v[196:197], v[26:27] op_sel_hi:[1,0]
  v_pk_mul_f32 v[198:199], v[198:199], v[26:27] op_sel_hi:[1,0]
  v_add_f32_dpp v22, v22, v22 row_ror:8 row_mask:0xf bank_mask:0xf
  v_mul_f32 v22, v22, v26
  v_mov_b32 v246, v22
  v_mov_b32 v247, v22
  s_nop 1
  v_permlane32_swap_b32 v246, v247
  v_add_f32 v246, v246, v247
  v_mov_b32 v247, v246
  s_nop 1
  v_permlane16_swap_b32 v246, v247
  v_add_f32 v245, v246, v247
  ds_write_b64 v241, v[244:245] offset:19584
  v_permlane32_swap_b32 v192, v196
  v_permlane32_swap_b32 v194, v198
  v_permlane32_swap_b32 v193, v197
  v_permlane32_swap_b32 v195, v199
  v_add_f32 v192, v192, v196
  v_add_f32 v194, v194, v198
  v_add_f32 v193, v193, v197
  v_add_f32 v195, v195, v199
  v_permlane16_swap_b32 v192, v194
  s_nop 0
  v_permlane16_swap_b32 v193, v195
  v_add_f32 v192, v192, v194
  v_add_f32 v193, v193, v195
  ds_write_b64 v240, v[192:193] offset:19584
  v_mov_b32 v246, v229
  v_mov_b32 v247, v229
  s_nop 1
  v_permlane32_swap_b32 v246, v247
  v_max_f32 v246, v246, v247
  v_mov_b32 v247, v246
  s_nop 1
  v_permlane16_swap_b32 v246, v247
  v_max_f32 v244, v246, v247
  v_sub_f32 v26, v229, v244
  v_exp_f32 v26, v26
  v_add_f32_dpp v22, v237, v237 row_ror:4 row_mask:0xf bank_mask:0xf
  v_pk_mul_f32 v[200:201], v[200:201], v[26:27] op_sel_hi:[1,0]
  v_pk_mul_f32 v[202:203], v[202:203], v[26:27] op_sel_hi:[1,0]
  v_pk_mul_f32 v[204:205], v[204:205], v[26:27] op_sel_hi:[1,0]
  v_pk_mul_f32 v[206:207], v[206:207], v[26:27] op_sel_hi:[1,0]
  v_add_f32_dpp v22, v22, v22 row_ror:8 row_mask:0xf bank_mask:0xf
  v_mul_f32 v22, v22, v26
  v_mov_b32 v246, v22
  v_mov_b32 v247, v22
  s_nop 1
  v_permlane32_swap_b32 v246, v247
  v_add_f32 v246, v246, v247
  v_mov_b32 v247, v246
  s_nop 1
  v_permlane16_swap_b32 v246, v247
  v_add_f32 v245, v246, v247
  ds_write_b64 v241, v[244:245] offset:21760
  v_permlane32_swap_b32 v200, v204
  v_permlane32_swap_b32 v202, v206
  v_permlane32_swap_b32 v201, v205
  v_permlane32_swap_b32 v203, v207
  v_add_f32 v200, v200, v204
  v_add_f32 v202, v202, v206
  v_add_f32 v201, v201, v205
  v_add_f32 v203, v203, v207
  v_permlane16_swap_b32 v200, v202
  s_nop 0
  v_permlane16_swap_b32 v201, v203
  v_add_f32 v200, v200, v202
  v_add_f32 v201, v201, v203
  ds_write_b64 v240, v[200:201] offset:21760
  v_mov_b32 v246, v230
  v_mov_b32 v247, v230
  s_nop 1
  v_permlane32_swap_b32 v246, v247
  v_max_f32 v246, v246, v247
  v_mov_b32 v247, v246
  s_nop 1
  v_permlane16_swap_b32 v246, v247
  v_max_f32 v244, v246, v247
  v_sub_f32 v26, v230, v244
  v_exp_f32 v26, v26
  v_add_f32_dpp v22, v238, v238 row_ror:4 row_mask:0xf bank_mask:0xf
  v_pk_mul_f32 v[208:209], v[208:209], v[26:27] op_sel_hi:[1,0]
  v_pk_mul_f32 v[210:211], v[210:211], v[26:27] op_sel_hi:[1,0]
  v_pk_mul_f32 v[212:213], v[212:213], v[26:27] op_sel_hi:[1,0]
  v_pk_mul_f32 v[214:215], v[214:215], v[26:27] op_sel_hi:[1,0]
  v_add_f32_dpp v22, v22, v22 row_ror:8 row_mask:0xf bank_mask:0xf
  v_mul_f32 v22, v22, v26
  v_mov_b32 v246, v22
  v_mov_b32 v247, v22
  s_nop 1
  v_permlane32_swap_b32 v246, v247
  v_add_f32 v246, v246, v247
  v_mov_b32 v247, v246
  s_nop 1
  v_permlane16_swap_b32 v246, v247
  v_add_f32 v245, v246, v247
  ds_write_b64 v241, v[244:245] offset:23936
  v_permlane32_swap_b32 v208, v212
  v_permlane32_swap_b32 v210, v214
  v_permlane32_swap_b32 v209, v213
  v_permlane32_swap_b32 v211, v215
  v_add_f32 v208, v208, v212
  v_add_f32 v210, v210, v214
  v_add_f32 v209, v209, v213
  v_add_f32 v211, v211, v215
  v_permlane16_swap_b32 v208, v210
  s_nop 0
  v_permlane16_swap_b32 v209, v211
  v_add_f32 v208, v208, v210
  v_add_f32 v209, v209, v211
  ds_write_b64 v240, v[208:209] offset:23936
  v_mov_b32 v246, v231
  v_mov_b32 v247, v231
  s_nop 1
  v_permlane32_swap_b32 v246, v247
  v_max_f32 v246, v246, v247
  v_mov_b32 v247, v246
  s_nop 1
  v_permlane16_swap_b32 v246, v247
  v_max_f32 v244, v246, v247
  v_sub_f32 v26, v231, v244
  v_exp_f32 v26, v26
  v_add_f32_dpp v22, v239, v239 row_ror:4 row_mask:0xf bank_mask:0xf
  v_pk_mul_f32 v[216:217], v[216:217], v[26:27] op_sel_hi:[1,0]
  v_pk_mul_f32 v[218:219], v[218:219], v[26:27] op_sel_hi:[1,0]
  v_pk_mul_f32 v[220:221], v[220:221], v[26:27] op_sel_hi:[1,0]
  v_pk_mul_f32 v[222:223], v[222:223], v[26:27] op_sel_hi:[1,0]
  v_add_f32_dpp v22, v22, v22 row_ror:8 row_mask:0xf bank_mask:0xf
  v_mul_f32 v22, v22, v26
  v_mov_b32 v246, v22
  v_mov_b32 v247, v22
  s_nop 1
  v_permlane32_swap_b32 v246, v247
  v_add_f32 v246, v246, v247
  v_mov_b32 v247, v246
  s_nop 1
  v_permlane16_swap_b32 v246, v247
  v_add_f32 v245, v246, v247
  ds_write_b64 v241, v[244:245] offset:26112
  v_permlane32_swap_b32 v216, v220
  v_permlane32_swap_b32 v218, v222
  v_permlane32_swap_b32 v217, v221
  v_permlane32_swap_b32 v219, v223
  v_add_f32 v216, v216, v220
  v_add_f32 v218, v218, v222
  v_add_f32 v217, v217, v221
  v_add_f32 v219, v219, v223
  v_permlane16_swap_b32 v216, v218
  s_nop 0
  v_permlane16_swap_b32 v217, v219
  v_add_f32 v216, v216, v218
  v_add_f32 v217, v217, v219
  ds_write_b64 v240, v[216:217] offset:26112
  s_waitcnt lgkmcnt(0)
  s_barrier
  s_branch L_p2
L_helper:
  s_setprio 3
  s_lshl_b32 s30, s2, 12
  v_mov_b32 v8, -1
  v_mov_b32 v9, -1
  v_mov_b32 v10, -1
  v_mov_b32 v11, -1
  s_mov_b32 s66, 1310720
  s_mov_b32 s67, 0x20000
  s_mov_b32 s78, 4096
  s_mov_b32 s79, 0x20000
  s_waitcnt lgkmcnt(0)
  s_mov_b32 s64, s28
  s_mov_b32 s65, s29
  buffer_store_dwordx4 v[8:11], v1, s[64:67], s30 offen offset:0 sc1
  buffer_store_dwordx4 v[8:11], v1, s[64:67], s30 offen offset:1024 sc1
  buffer_store_dwordx4 v[8:11], v1, s[64:67], s30 offen offset:2048 sc1
  buffer_store_dwordx4 v[8:11], v1, s[64:67], s30 offen offset:3072 sc1
  s_mov_b32 s76, s24
  s_mov_b32 s77, s25
  s_lshl_b32 s90, s84, 3
  s_add_u32 s80, s26, s90
  s_addc_u32 s81, s27, 0
  s_lshl_b32 s31, s84, 13
  s_add_u32 s31, s31, 1048576
  s_cmp_eq_u32 s95, 0
  s_cbranch_scc1 L_h_noclr
  s_add_u32 s93, s31, 4096
  buffer_store_dwordx4 v[8:11], v1, s[64:67], s31 offen offset:0 sc1
  buffer_store_dwordx4 v[8:11], v1, s[64:67], s31 offen offset:1024 sc1
  buffer_store_dwordx4 v[8:11], v1, s[64:67], s31 offen offset:2048 sc1
  buffer_store_dwordx4 v[8:11], v1, s[64:67], s31 offen offset:3072 sc1
  buffer_store_dwordx4 v[8:11], v1, s[64:67], s93 offen offset:0 sc1
  buffer_store_dwordx4 v[8:11], v1, s[64:67], s93 offen offset:1024 sc1
  buffer_store_dwordx4 v[8:11], v1, s[64:67], s93 offen offset:2048 sc1
  buffer_store_dwordx4 v[8:11], v1, s[64:67], s93 offen offset:3072 sc1
L_h_noclr:
  v_lshlrev_b32 v4, 2, v0
  v_lshlrev_b32 v5, 3, v0
  s_waitcnt vmcnt(0)
  v_mov_b32 v72, v1
  v_mov_b32 v3, v4
  v_mov_b32 v1, v5
  v_mov_b32 v2, 0
  s_mov_b32 s88, 1
  s_atomic_add s88, s[80:81], 0 glc
  s_waitcnt lgkmcnt(0)
  s_barrier
  ds_read_b64 v[8:9], v1 offset:0
  ds_read_b64 v[10:11], v1 offset:544
  ds_read_b64 v[12:13], v1 offset:1088
  ds_read_b64 v[14:15], v1 offset:1632
  s_waitcnt lgkmcnt(0)
  v_pk_add_f32 v[8:9], v[8:9], v[10:11]
  v_pk_add_f32 v[12:13], v[12:13], v[14:15]
  v_pk_add_f32 v[8:9], v[8:9], v[12:13]
  v_min_u32 v8, -2, v8
  v_min_u32 v9, -2, v9
  buffer_store_dwordx2 v[8:9], v1, s[64:67], s30 offen offset:0 sc1
  s_add_u32 s88, s88, 1
  s_mov_b32 s94, 2097152
L_h_flag:
  s_cmp_ge_u32 s88, 8
  s_cbranch_scc1 L_h_flag_ok
  s_mov_b32 s88, 0
  s_atomic_add s88, s[80:81], 0 glc
  s_sub_u32 s94, s94, 1
  s_waitcnt lgkmcnt(0)
  s_cbranch_scc0 L_h_flag
L_h_flag_ok:
  s_lshl_b32 s90, s84, 15
  s_mov_b32 s94, 2097152
L_h_qb:
  buffer_load_dwordx2 v[8:9], v1, s[64:67], s90 offen sc1
  s_add_u32 s93, s90, 4096
  buffer_load_dwordx2 v[10:11], v1, s[64:67], s93 offen sc1
  s_add_u32 s93, s90, 8192
  buffer_load_dwordx2 v[12:13], v1, s[64:67], s93 offen sc1
  s_add_u32 s93, s90, 12288
  buffer_load_dwordx2 v[14:15], v1, s[64:67], s93 offen sc1
  s_add_u32 s93, s90, 16384
  buffer_load_dwordx2 v[16:17], v1, s[64:67], s93 offen sc1
  s_add_u32 s93, s90, 20480
  buffer_load_dwordx2 v[18:19], v1, s[64:67], s93 offen sc1
  s_add_u32 s93, s90, 24576
  buffer_load_dwordx2 v[20:21], v1, s[64:67], s93 offen sc1
  s_add_u32 s93, s90, 28672
  buffer_load_dwordx2 v[22:23], v1, s[64:67], s93 offen sc1
  s_waitcnt vmcnt(0)
  v_max3_u32 v58, v8, v9, v10
  v_max3_u32 v58, v58, v11, v12
  v_max3_u32 v58, v58, v13, v14
  v_max3_u32 v58, v58, v15, v16
  v_max3_u32 v58, v58, v17, v18
  v_max3_u32 v58, v58, v19, v20
  v_max3_u32 v58, v58, v21, v22
  v_max_u32 v58, v58, v23
  v_cmp_eq_u32 vcc, -1, v58
  s_sub_u32 s94, s94, 1
  s_cbranch_scc1 L_h_qb_ok
  s_cbranch_vccnz L_h_qb
L_h_qb_ok:
  v_pk_add_f32 v[8:9], v[8:9], v[10:11]
  v_pk_add_f32 v[12:13], v[12:13], v[14:15]
  v_pk_add_f32 v[16:17], v[16:17], v[18:19]
  v_pk_add_f32 v[20:21], v[20:21], v[22:23]
  v_pk_add_f32 v[8:9], v[8:9], v[12:13]
  v_pk_add_f32 v[16:17], v[16:17], v[20:21]
  v_pk_add_f32 v[8:9], v[8:9], v[16:17]
  v_cvt_pk_bf16_f32 v8, v8, v9
  ds_write_b32 v3, v8 offset:28288
  s_waitcnt lgkmcnt(0)
  s_barrier
  ds_read_b64 v[8:9], v1 offset:2176
  ds_read_b64 v[10:11], v1 offset:2720
  ds_read_b64 v[12:13], v1 offset:3264
  ds_read_b64 v[14:15], v1 offset:3808
  s_waitcnt lgkmcnt(0)
  v_pk_add_f32 v[8:9], v[8:9], v[10:11]
  v_pk_add_f32 v[12:13], v[12:13], v[14:15]
  v_pk_add_f32 v[8:9], v[8:9], v[12:13]
  v_min_u32 v8, -2, v8
  v_min_u32 v9, -2, v9
  buffer_store_dwordx2 v[8:9], v1, s[64:67], s30 offen offset:512 sc1
  s_mov_b32 s94, 2097152
L_h_all:
  global_load_dword v12, v3, s[26:27] sc1
  s_waitcnt vmcnt(0)
  v_cmp_gt_u32 vcc, 8, v12
  s_nop 1
  s_and_b32 vcc_lo, vcc_lo, 0x55555555
  s_and_b32 vcc_hi, vcc_hi, 0x55555555
  s_sub_u32 s94, s94, 1
  s_cbranch_scc1 L_h_all_ok
  s_cmp_eq_u64 vcc, 0
  s_cbranch_scc0 L_h_all
L_h_all_ok:
  s_cmp_eq_u32 s95, 0
  s_cbranch_scc1 L_h_noaa
  s_lshr_b32 s90, s84, 3
  s_lshl_b32 s90, s90, 18
  s_add_u32 s90, s90, 512
  v_mov_b32 v6, v3
  s_mov_b32 s91, 8
L_h_qa_next:
  s_mov_b32 s94, 2097152
L_h_qa:
  buffer_load_dwordx2 v[8:9], v1, s[64:67], s90 offen sc1
  s_add_u32 s93, s90, 4096
  buffer_load_dwordx2 v[10:11], v1, s[64:67], s93 offen sc1
  s_add_u32 s93, s90, 8192
  buffer_load_dwordx2 v[12:13], v1, s[64:67], s93 offen sc1
  s_add_u32 s93, s90, 12288
  buffer_load_dwordx2 v[14:15], v1, s[64:67], s93 offen sc1
  s_add_u32 s93, s90, 16384
  buffer_load_dwordx2 v[16:17], v1, s[64:67], s93 offen sc1
  s_add_u32 s93, s90, 20480
  buffer_load_dwordx2 v[18:19], v1, s[64:67], s93 offen sc1
  s_add_u32 s93, s90, 24576
  buffer_load_dwordx2 v[20:21], v1, s[64:67], s93 offen sc1
  s_add_u32 s93, s90, 28672
  buffer_load_dwordx2 v[22:23], v1, s[64:67], s93 offen sc1
  s_waitcnt vmcnt(0)
  v_max3_u32 v58, v8, v9, v10
  v_max3_u32 v58, v58, v11, v12
  v_max3_u32 v58, v58, v13, v14
  v_max3_u32 v58, v58, v15, v16
  v_max3_u32 v58, v58, v17, v18
  v_max3_u32 v58, v58, v19, v20
  v_max3_u32 v58, v58, v21, v22
  v_max_u32 v58, v58, v23
  v_cmp_eq_u32 vcc, -1, v58
  s_sub_u32 s94, s94, 1
  s_cbranch_scc1 L_h_qa_ok
  s_cbranch_vccnz L_h_qa
L_h_qa_ok:
  v_pk_add_f32 v[8:9], v[8:9], v[10:11]
  v_pk_add_f32 v[12:13], v[12:13], v[14:15]
  v_pk_add_f32 v[16:17], v[16:17], v[18:19]
  v_pk_add_f32 v[20:21], v[20:21], v[22:23]
  v_pk_add_f32 v[8:9], v[8:9], v[12:13]
  v_pk_add_f32 v[16:17], v[16:17], v[20:21]
  v_pk_add_f32 v[8:9], v[8:9], v[16:17]
  v_cvt_pk_bf16_f32 v8, v8, v9
  ds_write_b32 v6, v8 offset:29056
  s_add_u32 s90, s90, 32768
  v_add_u32 v6, 256, v6
  s_sub_u32 s91, s91, 1
  s_cmp_lg_u32 s91, 0
  s_cbranch_scc1 L_h_qa_next
  s_waitcnt lgkmcnt(0)
  s_barrier
  s_barrier
  v_mov_b32 v6, v1
  v_mov_b32 v7, 0
  s_mov_b32 s91, 8
L_h_ap_next:
  ds_read_b64 v[40:41], v7 offset:11392
  ds_read_b64 v[42:43], v7 offset:11936
  ds_read_b64 v[44:45], v7 offset:12480
  ds_read_b64 v[46:47], v7 offset:13024
  ds_read_b64 v[8:9], v6 offset:10880
  ds_read_b64 v[10:11], v6 offset:11424
  ds_read_b64 v[12:13], v6 offset:11968
  ds_read_b64 v[14:15], v6 offset:12512
  s_waitcnt lgkmcnt(0)
  v_max3_f32 v70, v40, v42, v44
  v_max_f32 v70, v70, v46
  v_sub_f32 v58, v40, v70
  v_sub_f32 v59, v42, v70
  v_sub_f32 v60, v44, v70
  v_sub_f32 v61, v46, v70
  v_exp_f32 v58, v58
  v_exp_f32 v59, v59
  v_exp_f32 v60, v60
  v_exp_f32 v61, v61
  v_mul_f32 v71, v58, v41
  v_mul_f32 v68, v58, v8
  v_mul_f32 v69, v58, v9
  v_fmac_f32 v71, v59, v43
  v_fmac_f32 v68, v59, v10
  v_fmac_f32 v69, v59, v11
  v_fmac_f32 v71, v60, v45
  v_fmac_f32 v68, v60, v12
  v_fmac_f32 v69, v60, v13
  v_fmac_f32 v71, v61, v47
  v_fmac_f32 v68, v61, v14
  v_fmac_f32 v69, v61, v15
  v_min_u32 v68, -2, v68
  v_min_u32 v69, -2, v69
  v_min_u32 v70, -2, v70
  v_min_u32 v71, -2, v71
  buffer_store_dwordx4 v[68:71], v72, s[64:67], s31 offen offset:0 sc1
  s_add_u32 s31, s31, 1024
  v_add_u32 v6, 2176, v6
  v_add_u32 v7, 2176, v7
  s_sub_u32 s91, s91, 1
  s_cmp_lg_u32 s91, 0
  s_cbranch_scc1 L_h_ap_next
L_h_noaa:
  s_lshr_b32 s90, s84, 3
  s_lshl_b32 s90, s90, 16
  s_and_b32 s91, s84, 7
  s_lshl_b32 s91, s91, 10
  s_add_u32 s90, s90, s91
  s_add_u32 s90, s90, 1048576
  v_lshlrev_b32 v6, 13, v0
  s_mov_b32 s94, 2097152
  s_mov_b64 exec, 0xff
L_h_apw:
  buffer_load_dword v8, v6, s[64:67], s90 offen offset:12 sc1
  s_waitcnt vmcnt(0)
  v_cmp_eq_u32 vcc, -1, v8
  s_sub_u32 s94, s94, 1
  s_cbranch_scc1 L_h_apw_ok
  s_cbranch_vccnz L_h_apw
L_h_apw_ok:
  s_mov_b64 exec, -1
  s_mov_b32 s94, 2097152
L_h_ap8:
  buffer_load_dwordx4 v[8:11], v72, s[64:67], s90 offen sc1
  s_add_u32 s93, s90, 8192
  buffer_load_dwordx4 v[12:15], v72, s[64:67], s93 offen sc1
  s_add_u32 s93, s90, 16384
  buffer_load_dwordx4 v[16:19], v72, s[64:67], s93 offen sc1
  s_add_u32 s93, s90, 24576
  buffer_load_dwordx4 v[20:23], v72, s[64:67], s93 offen sc1
  s_add_u32 s93, s90, 32768
  buffer_load_dwordx4 v[24:27], v72, s[64:67], s93 offen sc1
  s_add_u32 s93, s90, 40960
  buffer_load_dwordx4 v[28:31], v72, s[64:67], s93 offen sc1
  s_add_u32 s93, s90, 49152
  buffer_load_dwordx4 v[32:35], v72, s[64:67], s93 offen sc1
  s_add_u32 s93, s90, 57344
  buffer_load_dwordx4 v[36:39], v72, s[64:67], s93 offen sc1
L_h_ap8_w:
  s_waitcnt vmcnt(0)
  v_max3_u32 v58, v8, v9, v10
  v_max3_u32 v58, v58, v11, v12
  v_max3_u32 v58, v58, v13, v14
  v_max3_u32 v58, v58, v15, v16
  v_max3_u32 v58, v58, v17, v18
  v_max3_u32 v58, v58, v19, v20
  v_max3_u32 v58, v58, v21, v22
  v_max3_u32 v58, v58, v23, v24
  v_max3_u32 v58, v58, v25, v26
  v_max3_u32 v58, v58, v27, v28
  v_max3_u32 v58, v58, v29, v30
  v_max3_u32 v58, v58, v31, v32
  v_max3_u32 v58, v58, v33, v34
  v_max3_u32 v58, v58, v35, v36
  v_max3_u32 v58, v58, v37, v38
  v_max_u32 v58, v58, v39
  v_cmp_eq_u32 vcc, -1, v58
  s_sub_u32 s94, s94, 1
  s_cbranch_scc1 L_h_ap8_ok
  s_cbranch_vccnz L_h_ap8
L_h_ap8_ok:
  v_max3_f32 v70, v10, v14, v18
  v_max3_f32 v70, v70, v22, v26
  v_max3_f32 v70, v70, v30, v34
  v_max_f32 v70, v70, v38
  v_sub_f32 v58, v10, v70
  v_sub_f32 v59, v14, v70
  v_sub_f32 v60, v18, v70
  v_sub_f32 v61, v22, v70
  v_sub_f32 v62, v26, v70
  v_sub_f32 v63, v30, v70
  v_sub_f32 v64, v34, v70
  v_sub_f32 v65, v38, v70
  v_exp_f32 v58, v58
  v_exp_f32 v59, v59
  v_exp_f32 v60, v60
  v_exp_f32 v61, v61
  v_exp_f32 v62, v62
  v_exp_f32 v63, v63
  v_exp_f32 v64, v64
  v_exp_f32 v65, v65
  v_mul_f32 v71, v58, v11
  v_mul_f32 v68, v58, v8
  v_mul_f32 v69, v58, v9
  v_fmac_f32 v71, v59, v15
  v_fmac_f32 v68, v59, v12
  v_fmac_f32 v69, v59, v13
  v_fmac_f32 v71, v60, v19
  v_fmac_f32 v68, v60, v16
  v_fmac_f32 v69, v60, v17
  v_fmac_f32 v71, v61, v23
  v_fmac_f32 v68, v61, v20
  v_fmac_f32 v69, v61, v21
  v_fmac_f32 v71, v62, v27
  v_fmac_f32 v68, v62, v24
  v_fmac_f32 v69, v62, v25
  v_fmac_f32 v71, v63, v31
  v_fmac_f32 v68, v63, v28
  v_fmac_f32 v69, v63, v29
  v_fmac_f32 v71, v64, v35
  v_fmac_f32 v68, v64, v32
  v_fmac_f32 v69, v64, v33
  v_fmac_f32 v71, v65, v39
  v_fmac_f32 v68, v65, v36
  v_fmac_f32 v69, v65, v37
  v_rcp_f32 v66, v71
  s_nop 0
  v_mul_f32 v68, v68, v66
  v_mul_f32 v69, v69, v66
  v_cvt_pk_bf16_f32 v68, v68, v69
  ds_write_b32 v3, v68 offset:28544
  s_lshl_b32 s90, s84, 15
  s_add_u32 s90, s90, 1024
  v_and_b32 v6, 31, v0
  v_lshlrev_b32 v6, 15, v6
  v_lshrrev_b32 v7, 5, v0
  v_lshl_add_u32 v6, v7, 9, v6
  s_lshl_b32 s91, s85, 12
  s_lshl_b32 s31, s84, 4
  s_add_u32 s91, s91, s31
  s_add_u32 s91, s91, 2048
  v_xor_b32 v7, 1, v7
  v_lshlrev_b32 v7, 11, v7
  s_lshl_b32 s31, s85, 8
  s_lshl_b32 s88, s84, 3
  s_add_u32 s31, s31, s88
  s_waitcnt lgkmcnt(0)
  s_barrier
  ds_read_b64 v[40:41], v2 offset:4864
  ds_read_b64 v[42:43], v2 offset:5408
  ds_read_b64 v[44:45], v2 offset:5952
  ds_read_b64 v[46:47], v2 offset:6496
  ds_read_b64 v[8:9], v1 offset:4352
  ds_read_b64 v[10:11], v1 offset:4896
  ds_read_b64 v[12:13], v1 offset:5440
  ds_read_b64 v[14:15], v1 offset:5984
  s_waitcnt lgkmcnt(0)
  v_max3_f32 v70, v40, v42, v44
  v_max_f32 v70, v70, v46
  v_sub_f32 v58, v40, v70
  v_sub_f32 v59, v42, v70
  v_sub_f32 v60, v44, v70
  v_sub_f32 v61, v46, v70
  v_exp_f32 v58, v58
  v_exp_f32 v59, v59
  v_exp_f32 v60, v60
  v_exp_f32 v61, v61
  v_mul_f32 v71, v58, v41
  v_mul_f32 v68, v58, v8
  v_mul_f32 v69, v58, v9
  v_fmac_f32 v71, v59, v43
  v_fmac_f32 v68, v59, v10
  v_fmac_f32 v69, v59, v11
  v_fmac_f32 v71, v60, v45
  v_fmac_f32 v68, v60, v12
  v_fmac_f32 v69, v60, v13
  v_fmac_f32 v71, v61, v47
  v_fmac_f32 v68, v61, v14
  v_fmac_f32 v69, v61, v15
  v_min_u32 v68, -2, v68
  v_min_u32 v69, -2, v69
  v_min_u32 v70, -2, v70
  v_min_u32 v71, -2, v71
  buffer_store_dwordx4 v[68:71], v72, s[64:67], s30 offen offset:1024 sc1
  s_barrier
  s_waitcnt lgkmcnt(0)
  s_barrier
  ds_read_b64 v[8:9], v1 offset:6528
  ds_read_b64 v[10:11], v1 offset:7072
  ds_read_b64 v[12:13], v1 offset:7616
  ds_read_b64 v[14:15], v1 offset:8160
  s_waitcnt lgkmcnt(0)
  v_pk_add_f32 v[8:9], v[8:9], v[10:11]
  v_pk_add_f32 v[12:13], v[12:13], v[14:15]
  v_pk_add_f32 v[8:9], v[8:9], v[12:13]
  v_min_u32 v8, -2, v8
  v_min_u32 v9, -2, v9
  buffer_store_dwordx2 v[8:9], v1, s[64:67], s30 offen offset:2560 sc1
  s_barrier
  ds_read_b64 v[8:9], v1 offset:8704
  ds_read_b64 v[10:11], v1 offset:9248
  ds_read_b64 v[12:13], v1 offset:9792
  ds_read_b64 v[14:15], v1 offset:10336
  s_waitcnt lgkmcnt(0)
  v_pk_add_f32 v[8:9], v[8:9], v[10:11]
  v_pk_add_f32 v[12:13], v[12:13], v[14:15]
  v_pk_add_f32 v[8:9], v[8:9], v[12:13]
  v_min_u32 v8, -2, v8
  v_min_u32 v9, -2, v9
  buffer_store_dwordx2 v[8:9], v1, s[64:67], s30 offen offset:2048 sc1
  s_mov_b32 s94, 2097152
L_h_fin:
  buffer_load_dwordx4 v[40:43], v6, s[64:67], s91 offen sc1
  s_waitcnt vmcnt(0)
  v_max3_u32 v58, v40, v41, v42
  v_max_u32 v58, v58, v43
  v_cmp_eq_u32 vcc, -1, v58
  s_sub_u32 s94, s94, 1
  s_cbranch_scc1 L_h_fin_ok
  s_cbranch_vccnz L_h_fin
L_h_fin_ok:
  v_add_f32_dpp v40, v40, v40 row_ror:8 row_mask:0xf bank_mask:0xf
  v_add_f32_dpp v41, v41, v41 row_ror:8 row_mask:0xf bank_mask:0xf
  v_add_f32_dpp v42, v42, v42 row_ror:8 row_mask:0xf bank_mask:0xf
  v_add_f32_dpp v43, v43, v43 row_ror:8 row_mask:0xf bank_mask:0xf
  v_add_f32_dpp v40, v40, v40 row_ror:4 row_mask:0xf bank_mask:0xf
  v_add_f32_dpp v41, v41, v41 row_ror:4 row_mask:0xf bank_mask:0xf
  v_add_f32_dpp v42, v42, v42 row_ror:4 row_mask:0xf bank_mask:0xf
  v_add_f32_dpp v43, v43, v43 row_ror:4 row_mask:0xf bank_mask:0xf
  v_add_f32_dpp v40, v40, v40 quad_perm:[2,3,0,1] row_mask:0xf bank_mask:0xf
  v_add_f32_dpp v41, v41, v41 quad_perm:[2,3,0,1] row_mask:0xf bank_mask:0xf
  v_add_f32_dpp v42, v42, v42 quad_perm:[2,3,0,1] row_mask:0xf bank_mask:0xf
  v_add_f32_dpp v43, v43, v43 quad_perm:[2,3,0,1] row_mask:0xf bank_mask:0xf
  v_add_f32_dpp v40, v40, v40 quad_perm:[1,0,3,2] row_mask:0xf bank_mask:0xf
  v_add_f32_dpp v41, v41, v41 quad_perm:[1,0,3,2] row_mask:0xf bank_mask:0xf
  v_add_f32_dpp v42, v42, v42 quad_perm:[1,0,3,2] row_mask:0xf bank_mask:0xf
  v_add_f32_dpp v43, v43, v43 quad_perm:[1,0,3,2] row_mask:0xf bank_mask:0xf
  v_mov_b32 v44, v40
  v_mov_b32 v45, v41
  v_mov_b32 v46, v42
  v_mov_b32 v47, v43
  v_permlane16_swap_b32 v40, v44
  v_permlane16_swap_b32 v41, v45
  v_permlane16_swap_b32 v42, v46
  v_permlane16_swap_b32 v43, v47
  v_add_f32 v40, v40, v44
  v_add_f32 v41, v41, v45
  v_add_f32 v42, v42, v46
  v_add_f32 v43, v43, v47
  v_cvt_pk_bf16_f32 v40, v40, v41
  v_cvt_pk_bf16_f32 v41, v42, v43
  s_mov_b32 exec_lo, 1
  s_mov_b32 exec_hi, 1
  buffer_store_dwordx2 v[40:41], v7, s[76:79], s31 offen
L_end:
  s_endpgm
.section .rodata,"a"
.p2align 6
.amdhsa_kernel concat_heads__sliding_block_cached__mha_block_cached__decode_kernel
  .amdhsa_next_free_vgpr 256
  .amdhsa_next_free_sgpr 102
  .amdhsa_accum_offset 256
  .amdhsa_group_segment_fixed_size 0
  .amdhsa_kernarg_size 104
  .amdhsa_user_sgpr_count 2
  .amdhsa_user_sgpr_kernarg_segment_ptr 1
  .amdhsa_system_sgpr_workgroup_id_x 1
.end_amdhsa_kernel
```
